```python
import torch

def _softmax(x, axis=-1):
    return torch.softmax(x, dim=axis)
def _gelu(x):
    return torch.nn.functional.gelu(x, approximate="tanh")
def _silu(x):
    return torch.nn.functional.silu(x)
def _sigmoid(x):
    return torch.sigmoid(x)
def _layernorm(x, axis=-1, eps=1e-5):
    m = x.mean(dim=axis, keepdim=True)
    v = x.var(dim=axis, keepdim=True, unbiased=False)
    return (x - m) / torch.sqrt(v + eps)
def _scatter_add(tgt, idx, src, axis=0):
    return tgt.clone().index_add_(axis, idx, src)
def _segment_sum(src, seg, n):
    out = torch.zeros((n,) + src.shape[1:], dtype=src.dtype)
    return out.index_add_(0, seg, src)
def _pad(x, pw):
    flat = tuple(v for pair in reversed(pw) for v in pair)
    return torch.nn.functional.pad(x, flat)

kernel_name = 'concat_heads__ssm_conv_h3__ssm_conv_s4__prompt'

def setup_inputs():

    _w = (lambda a: (lambda t: t.to(torch.bfloat16) if t.is_floating_point() else t)(torch.as_tensor(a)))
    def _A_setup():
        B, S, D = 1, 2048, 640
        ks = 4
        return {
            "q": _w((lambda *s: torch.randn(*s, dtype=torch.bfloat16) * 0.05)(B, S, D)),
            "k": _w((lambda *s: torch.randn(*s, dtype=torch.bfloat16) * 0.2)(B, S, D)),
            "v": _w((lambda *s: torch.randn(*s, dtype=torch.bfloat16) * 0.2)(B, S, D)),
            "shift_k": _w((lambda *s: torch.randn(*s, dtype=torch.bfloat16) * 0.2)(D, ks) * 0.5),
            "ssm_k": _w((lambda *s: torch.randn(*s, dtype=torch.bfloat16) * 0.8)(D, S) * (1.0 / S ** 0.5)),
            "ssm_D": _w((lambda *s: torch.randn(*s, dtype=torch.bfloat16) * 0.2)(D)),
        }
    _A_in = _A_setup()

    def _B_setup():
        B, L, D, N = 1, 2048, 640, 128
        A_re = -(lambda _x: torch.exp(torch.as_tensor(_x)))((lambda *s: torch.randn(*s, dtype=torch.bfloat16) * 3.2)(D, N))
        A_im = torch.pi * (lambda *s: torch.randn(*s, dtype=torch.bfloat16) * 0.05)(D, N)
        B_re = (lambda *s: torch.randn(*s, dtype=torch.bfloat16) * 0.1)(D, N)
        B_im = (lambda *s: torch.randn(*s, dtype=torch.bfloat16) * 0.1)(D, N)
        C_re = (lambda *s: torch.randn(*s, dtype=torch.bfloat16) * 0.1)(D, N)
        C_im = (lambda *s: torch.randn(*s, dtype=torch.bfloat16) * 0.1)(D, N)
        log_dt = (lambda *s: torch.randn(*s, dtype=torch.bfloat16) * 0.05)(D) * 0.5 - 4.0
        Dskip = (lambda *s: torch.randn(*s, dtype=torch.bfloat16) * 0.05)(D)
        return {
            "u": _w((lambda *s: torch.randn(*s, dtype=torch.bfloat16) * 0.05)(B, L, D)),
            "A_re": _w(A_re),
            "A_im": _w(A_im),
            "B_re": _w(B_re),
            "B_im": _w(B_im),
            "C_re": _w(C_re),
            "C_im": _w(C_im),
            "log_dt": _w(log_dt),
            "Dskip": _w(Dskip),
        }
    _B_in = _B_setup()

    return {
        "A_q": _A_in["q"],
        "A_k": _A_in["k"],
        "A_v": _A_in["v"],
        "A_shift_k": _A_in["shift_k"],
        "A_ssm_k": _A_in["ssm_k"],
        "A_ssm_D": _A_in["ssm_D"],
        "B_u": _B_in["u"],
        "B_A_re": _B_in["A_re"],
        "B_A_im": _B_in["A_im"],
        "B_B_re": _B_in["B_re"],
        "B_B_im": _B_in["B_im"],
        "B_C_re": _B_in["C_re"],
        "B_C_im": _B_in["C_im"],
        "B_log_dt": _B_in["log_dt"],
        "B_Dskip": _B_in["Dskip"],
    }

def reference(A_q, A_k, A_v, A_shift_k, A_ssm_k, A_ssm_D, B_u, B_A_re, B_A_im, B_B_re, B_B_im, B_C_re, B_C_im, B_log_dt, B_Dskip):
    def _A_ref(q, k, v, shift_k, ssm_k, ssm_D):
        B, S, D = q.shape
        ks = shift_k.shape[-1]
        k_pad = _pad(k, ((0, 0), (ks - 1, 0), (0, 0)))
        k_shift = torch.zeros_like(k)
        for t in range(ks):
            k_shift = k_shift + k_pad[:, t:t + S, :] * shift_k[:, ks - 1 - t][None, None, :]
        kv = k_shift * v
        L = 2 * S
        kv_pad = _pad(kv, ((0, 0), (0, S), (0, 0)))
        kf_pad = _pad(ssm_k, ((0, 0), (0, S)))
        kv_f = (lambda x, axes=(-2,-1): torch.fft.rfft2(x.float(), dim=axes))(kv_pad[:, None, :, :], axes=(1, 2))
        kf_f = (lambda x, axes=(-2,-1): torch.fft.rfft2(x.float(), dim=axes))(kf_pad[:, None, :], axes=(1, 2))
        kf_f = (lambda x, *d: x.permute(*d))(kf_f, 1, 2, 0)
        y_f = kv_f * kf_f[None, :, :, :]
        y = (lambda x, s, axes=(-2,-1): torch.fft.irfft2(x, s=s, dim=axes).to(torch.bfloat16))(y_f, (1, L), axes=(1, 2))[:, 0, :S, :]
        y = y + kv * ssm_D[None, None, :]
        return q * y

    def _B_ref(u, A_re, A_im, B_re, B_im, C_re, C_im, log_dt, Dskip):
        Bsz, L, D = u.shape
        dt = torch.exp(log_dt)[:, None]
        A = A_re + 1j * A_im
        Bc = B_re + 1j * B_im
        Cc = C_re + 1j * C_im
        logdA = dt * A
        dB = dt * Bc
        l = (lambda x, dt: x.to(dt))(torch.arange(L), A_re.dtype)
        P = torch.exp(logdA[:, :, None] * l[None, None, :])
        K = torch.einsum("dn,dnl,dn->dl", Cc, P, dB).real
        L2 = 2 * L
        Kp = _pad(K, ((0, 0), (0, L)))
        up = (lambda x, *d: x.permute(*d))(u, 0, 2, 1)
        up = _pad(up, ((0, 0), (0, 0), (0, L)))
        Kf = (lambda x, axes=(-2,-1): torch.fft.rfft2(x.float(), dim=axes))(Kp[:, None, :], axes=(-2, -1))
        Uf = (lambda x, axes=(-2,-1): torch.fft.rfft2(x.float(), dim=axes))(up[:, :, None, :], axes=(-2, -1))
        Yf = Uf * Kf[None, :, :, :]
        y = (lambda x, s, axes=(-2,-1): torch.fft.irfft2(x, s=s, dim=axes).to(torch.bfloat16))(Yf, (1, L2), axes=(-2, -1))[:, :, 0, :L]
        y = (lambda x, *d: x.permute(*d))(y, 0, 2, 1) + u * Dskip[None, None, :]
        return y

    a = _A_ref(A_q, A_k, A_v, A_shift_k, A_ssm_k, A_ssm_D)
    b = _B_ref(B_u, B_A_re, B_A_im, B_B_re, B_B_im, B_C_re, B_C_im, B_log_dt, B_Dskip)
    return torch.concatenate([a, b], axis=-1)
```

```asm
; @launch grid=(256,1,1) block=(512,1,1) lds=155264
.amdgcn_target "amdgcn-amd-amdhsa--gfx950"
.text
.globl concat_heads__ssm_conv_h3__ssm_conv_s4__prompt_kernel
.p2align 8
.type concat_heads__ssm_conv_h3__ssm_conv_s4__prompt_kernel,@function
concat_heads__ssm_conv_h3__ssm_conv_s4__prompt_kernel:
    s_load_dwordx16 s[32:47], s[0:1], 0
    s_load_dwordx16 s[48:63], s[0:1], 64
    s_and_b32 s5, s2, 7
    s_lshr_b32 s6, s2, 3
    v_lshrrev_b32 v2, 6, v0
    v_and_b32 v1, 63, v0
    s_cmp_lt_u32 s5, 4
    s_cselect_b32 s7, 3, 2
    v_readfirstlane_b32 s4, v2
    s_mul_i32 s64, s5, 3
    s_lshl_b32 s65, s5, 1
    s_add_u32 s66, s65, 4
    s_cmp_lt_u32 s5, 4
    s_cselect_b32 s66, s64, s66
    s_sub_u32 s67, s64, 4
    s_cmp_lt_u32 s5, 4
    s_cselect_b32 s67, s65, s67
    s_lshl_b32 s68, s7, 2
    s_sub_u32 s69, 5, s7
    s_lshl_b32 s70, s69, 3
    s_add_u32 s70, s70, s68
    s_cmp_ge_u32 s6, s70
    s_cbranch_scc1 L_end
    v_mov_b32 v13, 0
    v_mov_b32 v14, 1
    s_mov_b32 s97, 0
    v_lshlrev_b32 v2, 2, v1
    v_and_b32 v2, 127, v2
    ds_write_b32 v2, v13 offset:0
    v_lshlrev_b32 v13, 2, v1
    v_add_u32 v13, 128, v13
    v_writelane_b32 v13, 0, 0
    s_waitcnt lgkmcnt(0)
    s_cmp_ge_u32 s6, s68
    s_cbranch_scc1 L_B
    s_lshr_b32 s71, s6, 2
    s_add_u32 s71, s71, s66
    s_and_b32 s72, s6, 3
    s_lshl_b32 s71, s71, 5
    s_lshl_b32 s72, s72, 3
    s_add_u32 s3, s71, s72
    s_mov_b32 s20, s40
    s_mov_b32 s21, s41
    s_mov_b32 s22, 2621440
    s_mov_b32 s23, 0x00020000
    s_add_u32 s7, s3, s4
    s_lshl_b32 s7, s7, 12
    v_lshlrev_b32 v2, 4, v1
    buffer_load_dwordx4 v[96:99], v2, s[20:23], s7 offen offset:0
    buffer_load_dwordx4 v[100:103], v2, s[20:23], s7 offen offset:1024
    buffer_load_dwordx4 v[104:107], v2, s[20:23], s7 offen offset:2048
    buffer_load_dwordx4 v[108:111], v2, s[20:23], s7 offen offset:3072
    s_lshl_b32 s5, s3, 3
    s_lshl_b32 s6, s3, 1
    s_mul_i32 s7, s4, 327680
    s_add_u32 s7, s7, s6
    s_load_dwordx16 s[64:79], s[38:39], s5
    s_load_dwordx4 s[80:83], s[42:43], s6
    s_sub_u32 s5, s7, 3840
    s_cmp_eq_u32 s4, 0
    s_cselect_b32 s5, s6, s5
    s_add_u32 s28, s5, 1280
    s_add_u32 s29, s5, 2560
    s_load_dwordx4 s[84:87], s[34:35], s5
    s_load_dwordx4 s[88:91], s[34:35], s28
    s_load_dwordx4 s[92:95], s[34:35], s29
    s_mov_b32 s8, s34
    s_mov_b32 s9, s35
    s_mov_b32 s10, 2621440
    s_mov_b32 s11, 0x00020000
    s_mov_b32 s12, s36
    s_mov_b32 s13, s37
    s_mov_b32 s14, 2621440
    s_mov_b32 s15, 0x00020000
    s_mov_b32 s16, s32
    s_mov_b32 s17, s33
    s_mov_b32 s18, 2621440
    s_mov_b32 s19, 0x00020000
    s_mov_b32 s24, s62
    s_mov_b32 s25, s63
    s_mov_b32 s26, 5242880
    s_mov_b32 s27, 0x00020000
    v_mul_u32_u24 v3, 5120, v1
    v_add_u32 v3, s7, v3
    s_barrier
    s_cmp_ge_u32 s4, 2
    s_cbranch_scc1 L_A_skipx
    buffer_load_dwordx4 v[16:19], v3, s[8:11], 0 offen offset:0
    buffer_load_dwordx4 v[20:23], v3, s[8:11], 0 offen offset:1280
    buffer_load_dwordx4 v[24:27], v3, s[8:11], 0 offen offset:2560
    buffer_load_dwordx4 v[28:31], v3, s[8:11], 0 offen offset:3840
    buffer_load_dwordx4 v[32:35], v3, s[12:15], 0 offen offset:0
    buffer_load_dwordx4 v[36:39], v3, s[12:15], 0 offen offset:1280
    buffer_load_dwordx4 v[40:43], v3, s[12:15], 0 offen offset:2560
    buffer_load_dwordx4 v[44:47], v3, s[12:15], 0 offen offset:3840
L_A_skipx:
    s_mul_i32 s28, s4, 8448
    s_add_u32 s28, s28, 640
    s_mul_i32 s29, s4, 4608
    s_add_u32 s29, s29, 68224
    v_mov_b32 v6, 0
    v_mov_b32 v7, 0
    v_lshlrev_b32 v48, 3, v1
    v_add_u32 v48, s29, v48
    ds_write_b64 v48, v[6:7] offset:4096
    v_and_b32 v48, 15, v1
    v_lshrrev_b32 v49, 4, v1
    v_add_u32 v50, 1, v48
    v_lshrrev_b32 v50, 2, v50
    v_lshl_add_u32 v50, v49, 1, v50
    v_lshlrev_b32 v50, 3, v50
    v_add_u32 v51, 1, v48
    v_and_b32 v51, 3, v51
    v_mul_u32_u24 v51, 2112, v51
    v_add3_u32 v8, v50, v51, s28
    v_lshlrev_b32 v50, 5, v48
    v_lshlrev_b32 v51, 4, v49
    v_sub_u32 v51, v51, v50
    v_add_u32 v51, 480, v51
    v_add_u32 v12, s29, v51
    v_mov_b32 v10, v2
    s_waitcnt lgkmcnt(0)
    s_lshl_b32 s5, s4, 9
    s_sub_u32 s5, 72312, s5
    v_lshlrev_b32 v4, 3, v1
    s_lshl_b32 s30, s4, 12
    s_add_u32 s30, s30, 105088
    v_add_u32 v5, s30, v4
    v_sub_u32 v4, s5, v4
    v_and_b32 v6, 3, v1
    v_lshrrev_b32 v7, 2, v1
    v_lshl_add_u32 v6, v6, 4, v7
    v_lshlrev_b32 v6, 3, v6
    s_lshl_b32 s5, s4, 9
    s_add_u32 s5, s5, 105088
    v_add_u32 v6, s5, v6
    s_lshl_b32 s30, s4, 2
    v_add_u32 v7, s30, v13
    s_lshl_b32 s32, s64, 16
    s_lshl_b32 s33, s66, 16
    s_and_b32 s34, s64, 0xffff0000
    s_and_b32 s35, s66, 0xffff0000
    s_lshl_b32 s36, s65, 16
    s_lshl_b32 s37, s67, 16
    s_and_b32 s38, s65, 0xffff0000
    s_and_b32 s39, s67, 0xffff0000
    s_lshl_b32 s40, s68, 16
    s_lshl_b32 s41, s70, 16
    s_and_b32 s42, s68, 0xffff0000
    s_and_b32 s43, s70, 0xffff0000
    s_lshl_b32 s44, s69, 16
    s_lshl_b32 s45, s71, 16
    s_and_b32 s46, s69, 0xffff0000
    s_and_b32 s47, s71, 0xffff0000
    s_lshl_b32 s48, s72, 16
    s_lshl_b32 s49, s74, 16
    s_and_b32 s50, s72, 0xffff0000
    s_and_b32 s51, s74, 0xffff0000
    s_lshl_b32 s52, s73, 16
    s_lshl_b32 s53, s75, 16
    s_and_b32 s54, s73, 0xffff0000
    s_and_b32 s55, s75, 0xffff0000
    s_lshl_b32 s56, s76, 16
    s_lshl_b32 s57, s78, 16
    s_and_b32 s58, s76, 0xffff0000
    s_and_b32 s59, s78, 0xffff0000
    s_lshl_b32 s60, s77, 16
    s_lshl_b32 s61, s79, 16
    s_and_b32 s62, s77, 0xffff0000
    s_and_b32 s63, s79, 0xffff0000
    s_lshr_b32 s5, s4, 1
    s_cmp_eq_u32 s5, 1
    s_cselect_b32 s30, s81, s80
    s_cmp_eq_u32 s5, 2
    s_cselect_b32 s30, s82, s30
    s_cmp_eq_u32 s5, 3
    s_cselect_b32 s30, s83, s30
    s_and_b32 s5, s4, 1
    s_lshl_b32 s5, s5, 4
    s_lshr_b32 s30, s30, s5
    s_and_b32 s30, s30, 0xffff
    v_and_b32 v48, 15, v1
    v_lshrrev_b32 v49, 4, v1
    v_lshlrev_b32 v49, 3, v49
    v_add_u32 v48, v48, v49
    v_sub_u32 v48, 15, v48
    v_and_b32 v49, 1, v48
    v_lshlrev_b32 v49, 4, v49
    v_lshlrev_b32_e64 v49, v49, s30
    v_ashrrev_i32 v48, 1, v48
    v_cmp_eq_u32 vcc, 0, v48
    s_nop 1
    v_cndmask_b32 v74, 0, v49, vcc
    v_cmp_eq_u32 vcc, 1, v48
    s_nop 1
    v_cndmask_b32 v75, 0, v49, vcc
    v_cmp_eq_u32 vcc, 2, v48
    s_nop 1
    v_cndmask_b32 v76, 0, v49, vcc
    v_cmp_eq_u32 vcc, 3, v48
    s_nop 1
    v_cndmask_b32 v77, 0, v49, vcc
    s_cmp_lg_u32 s4, 0
    s_cbranch_scc1 L_A_halo_ok
    s_mov_b32 s84, 0
    s_mov_b32 s85, 0
    s_mov_b32 s86, 0
    s_mov_b32 s87, 0
    s_mov_b32 s88, 0
    s_mov_b32 s89, 0
    s_mov_b32 s90, 0
    s_mov_b32 s91, 0
    s_mov_b32 s92, 0
    s_mov_b32 s93, 0
    s_mov_b32 s94, 0
    s_mov_b32 s95, 0
L_A_halo_ok:
    s_cmp_lt_u32 s4, 2
    s_cbranch_scc1 L_A_nostage
    s_waitcnt vmcnt(0)
    s_cmp_ge_u32 s4, 4
    s_cbranch_scc1 L_A_kw2
    buffer_load_dwordx4 v[16:19], v3, s[8:11], 0 offen offset:0
    buffer_load_dwordx4 v[20:23], v3, s[8:11], 0 offen offset:1280
    buffer_load_dwordx4 v[24:27], v3, s[8:11], 0 offen offset:2560
    buffer_load_dwordx4 v[28:31], v3, s[8:11], 0 offen offset:3840
    buffer_load_dwordx4 v[32:35], v3, s[12:15], 0 offen offset:0
    buffer_load_dwordx4 v[36:39], v3, s[12:15], 0 offen offset:1280
    buffer_load_dwordx4 v[40:43], v3, s[12:15], 0 offen offset:2560
    buffer_load_dwordx4 v[44:47], v3, s[12:15], 0 offen offset:3840
L_A_kw2:
    v_add_u32 v9, s28, v10
    v_readlane_b32 s64, v96, 0
    v_readlane_b32 s65, v97, 0
    v_readlane_b32 s66, v100, 0
    v_readlane_b32 s67, v101, 0
    v_readlane_b32 s68, v104, 0
    v_readlane_b32 s69, v105, 0
    v_readlane_b32 s70, v108, 0
    v_readlane_b32 s71, v109, 0
    v_alignbit_b32 v112, v97, v96, 16
    v_alignbit_b32 v113, v98, v97, 16
    v_alignbit_b32 v114, v99, v98, 16
    v_alignbit_b32 v116, v101, v100, 16
    v_alignbit_b32 v117, v102, v101, 16
    v_alignbit_b32 v118, v103, v102, 16
    v_alignbit_b32 v120, v105, v104, 16
    v_alignbit_b32 v121, v106, v105, 16
    v_alignbit_b32 v122, v107, v106, 16
    v_alignbit_b32 v124, v109, v108, 16
    v_alignbit_b32 v125, v110, v109, 16
    v_alignbit_b32 v126, v111, v110, 16
    v_mov_b32 v64, s66
    v_mov_b32 v65, s67
    v_mov_b32 v66, s68
    v_mov_b32 v67, s69
    v_mov_b32 v68, s70
    v_mov_b32 v69, s71
    v_mov_b32 v70, s70
    v_mov_b32 v71, s71
    s_nop 0
    v_mov_b32_dpp v64, v96 wave_shl:1 row_mask:0xf bank_mask:0xf
    v_mov_b32_dpp v65, v97 wave_shl:1 row_mask:0xf bank_mask:0xf
    v_mov_b32_dpp v66, v100 wave_shl:1 row_mask:0xf bank_mask:0xf
    v_mov_b32_dpp v67, v101 wave_shl:1 row_mask:0xf bank_mask:0xf
    v_mov_b32_dpp v68, v104 wave_shl:1 row_mask:0xf bank_mask:0xf
    v_mov_b32_dpp v69, v105 wave_shl:1 row_mask:0xf bank_mask:0xf
    v_mov_b32_dpp v70, v108 wave_shl:1 row_mask:0xf bank_mask:0xf
    v_mov_b32_dpp v71, v109 wave_shl:1 row_mask:0xf bank_mask:0xf
    v_alignbit_b32 v115, v64, v99, 16
    v_pk_mov_b32 v[80:81], v[96:97], v[98:99] op_sel:[1,0]
    v_pk_mov_b32 v[82:83], v[98:99], v[64:65] op_sel:[1,0]
    v_alignbit_b32 v119, v66, v103, 16
    v_pk_mov_b32 v[84:85], v[100:101], v[102:103] op_sel:[1,0]
    v_pk_mov_b32 v[86:87], v[102:103], v[66:67] op_sel:[1,0]
    v_alignbit_b32 v123, v68, v107, 16
    v_pk_mov_b32 v[88:89], v[104:105], v[106:107] op_sel:[1,0]
    v_pk_mov_b32 v[90:91], v[106:107], v[68:69] op_sel:[1,0]
    v_alignbit_b32 v127, v70, v111, 16
    v_pk_mov_b32 v[92:93], v[108:109], v[110:111] op_sel:[1,0]
    v_pk_mov_b32 v[94:95], v[110:111], v[70:71] op_sel:[1,0]
    v_alignbit_b32 v64, v65, v64, 16
    v_alignbit_b32 v66, v67, v66, 16
    v_alignbit_b32 v68, v69, v68, 16
    v_alignbit_b32 v70, v71, v70, 16
    v_pk_mov_b32 v[48:49], v[112:113], v[114:115] op_sel:[1,0]
    v_pk_mov_b32 v[50:51], v[114:115], v[64:65] op_sel:[1,0]
    v_pk_mov_b32 v[52:53], v[116:117], v[118:119] op_sel:[1,0]
    v_pk_mov_b32 v[54:55], v[118:119], v[66:67] op_sel:[1,0]
    v_pk_mov_b32 v[56:57], v[120:121], v[122:123] op_sel:[1,0]
    v_pk_mov_b32 v[58:59], v[122:123], v[68:69] op_sel:[1,0]
    v_pk_mov_b32 v[60:61], v[124:125], v[126:127] op_sel:[1,0]
    v_pk_mov_b32 v[62:63], v[126:127], v[70:71] op_sel:[1,0]
    ds_write_b128 v9, v[104:107] offset:32
    ds_write_b128 v9, v[120:123] offset:2144
    ds_write_b128 v9, v[88:91] offset:4256
    ds_write_b128 v9, v[56:59] offset:6368
    ds_write_b128 v9, v[108:111] offset:1056
    ds_write_b128 v9, v[124:127] offset:3168
    ds_write_b128 v9, v[92:95] offset:5280
    ds_write_b128 v9, v[60:63] offset:7392
    v_subrev_u32 v72, 992, v9
    s_mov_b32 exec_lo, 0
    s_mov_b32 exec_hi, 0xc0000000
    ds_write_b128 v72, v[100:103] offset:0
    ds_write_b128 v72, v[116:119] offset:2112
    ds_write_b128 v72, v[84:87] offset:4224
    ds_write_b128 v72, v[52:55] offset:6336
    s_mov_b64 exec, -1
    ds_read_b64 v[128:129], v8 offset:1536
    ds_read_b64 v[130:131], v8 offset:1544
    ds_read_b64 v[160:161], v8 offset:1024
    ds_read_b64 v[162:163], v8 offset:1032
    ds_read_b64 v[192:193], v8 offset:512
    ds_read_b64 v[194:195], v8 offset:520
    ds_read_b64 v[224:225], v8 offset:0
    ds_read_b64 v[226:227], v8 offset:8
    ds_read_b64 v[132:133], v8 offset:1600
    ds_read_b64 v[134:135], v8 offset:1608
    ds_read_b64 v[164:165], v8 offset:1088
    ds_read_b64 v[166:167], v8 offset:1096
    ds_read_b64 v[196:197], v8 offset:576
    ds_read_b64 v[198:199], v8 offset:584
    ds_read_b64 v[228:229], v8 offset:64
    ds_read_b64 v[230:231], v8 offset:72
    ds_read_b64 v[136:137], v8 offset:1664
    ds_read_b64 v[138:139], v8 offset:1672
    ds_read_b64 v[168:169], v8 offset:1152
    ds_read_b64 v[170:171], v8 offset:1160
    ds_read_b64 v[200:201], v8 offset:640
    ds_read_b64 v[202:203], v8 offset:648
    ds_read_b64 v[232:233], v8 offset:128
    ds_read_b64 v[234:235], v8 offset:136
    ds_read_b64 v[140:141], v8 offset:1728
    ds_read_b64 v[142:143], v8 offset:1736
    ds_read_b64 v[172:173], v8 offset:1216
    ds_read_b64 v[174:175], v8 offset:1224
    ds_read_b64 v[204:205], v8 offset:704
    ds_read_b64 v[206:207], v8 offset:712
    ds_read_b64 v[236:237], v8 offset:192
    ds_read_b64 v[238:239], v8 offset:200
    ds_read_b64 v[144:145], v8 offset:1792
    ds_read_b64 v[146:147], v8 offset:1800
    ds_read_b64 v[176:177], v8 offset:1280
    ds_read_b64 v[178:179], v8 offset:1288
    ds_read_b64 v[208:209], v8 offset:768
    ds_read_b64 v[210:211], v8 offset:776
    ds_read_b64 v[240:241], v8 offset:256
    ds_read_b64 v[242:243], v8 offset:264
    ds_read_b64 v[148:149], v8 offset:1856
    ds_read_b64 v[150:151], v8 offset:1864
    ds_read_b64 v[180:181], v8 offset:1344
    ds_read_b64 v[182:183], v8 offset:1352
    ds_read_b64 v[212:213], v8 offset:832
    ds_read_b64 v[214:215], v8 offset:840
    ds_read_b64 v[244:245], v8 offset:320
    ds_read_b64 v[246:247], v8 offset:328
    ds_read_b64 v[152:153], v8 offset:1920
    ds_read_b64 v[154:155], v8 offset:1928
    ds_read_b64 v[184:185], v8 offset:1408
    ds_read_b64 v[186:187], v8 offset:1416
    ds_read_b64 v[216:217], v8 offset:896
    ds_read_b64 v[218:219], v8 offset:904
    ds_read_b64 v[248:249], v8 offset:384
    ds_read_b64 v[250:251], v8 offset:392
    ds_read_b64 v[156:157], v8 offset:1984
    ds_read_b64 v[158:159], v8 offset:1992
    ds_read_b64 v[188:189], v8 offset:1472
    ds_read_b64 v[190:191], v8 offset:1480
    ds_read_b64 v[220:221], v8 offset:960
    ds_read_b64 v[222:223], v8 offset:968
    ds_read_b64 v[252:253], v8 offset:448
    ds_read_b64 v[254:255], v8 offset:456
    ds_write_b128 v9, v[96:99] offset:32
    ds_write_b128 v9, v[112:115] offset:2144
    ds_write_b128 v9, v[80:83] offset:4256
    ds_write_b128 v9, v[48:51] offset:6368
    ds_write_b128 v9, v[100:103] offset:1056
    ds_write_b128 v9, v[116:119] offset:3168
    ds_write_b128 v9, v[84:87] offset:5280
    ds_write_b128 v9, v[52:55] offset:7392
    v_lshlrev_b32 v9, 2, v1
    v_add_u32 v9, s28, v9
    v_readlane_b32 s30, v96, 0
    v_readlane_b32 s31, v112, 0
    v_mov_b32 v64, 0
    v_mov_b32 v65, 0
    v_mov_b32 v66, 0
    v_mov_b32 v67, 0
    s_lshl_b32 s5, s30, 16
    v_writelane_b32 v65, s5, 7
    v_writelane_b32 v66, s30, 7
    v_writelane_b32 v67, s5, 6
    v_writelane_b32 v67, s31, 7
    s_mov_b64 exec, 0xff
    ds_write_b32 v9, v64 offset:0
    ds_write_b32 v9, v65 offset:2112
    ds_write_b32 v9, v66 offset:4224
    ds_write_b32 v9, v67 offset:6336
    s_mov_b64 exec, -1
L_A_nostage:
    s_cmp_ge_u32 s4, 4
    s_cbranch_scc1 L_A_hi
    s_waitcnt vmcnt(0)
    v_mov_b32 v48, s84
    v_mov_b32 v49, s88
    v_mov_b32 v50, s92
    v_lshlrev_b32 v58, 16, v16
    v_and_b32 v59, 0xffff0000, v16
    v_lshlrev_b32 v60, 16, v20
    v_and_b32 v61, 0xffff0000, v20
    v_lshlrev_b32 v62, 16, v24
    v_and_b32 v63, 0xffff0000, v24
    v_lshlrev_b32 v64, 16, v28
    v_and_b32 v65, 0xffff0000, v28
    v_mov_b32_dpp v48, v20 wave_shr:1 row_mask:0xf bank_mask:0xf
    v_mov_b32_dpp v49, v24 wave_shr:1 row_mask:0xf bank_mask:0xf
    v_mov_b32_dpp v50, v28 wave_shr:1 row_mask:0xf bank_mask:0xf
    v_pk_mul_f32 v[66:67], s[32:33], v[58:59]
    v_pk_mul_f32 v[68:69], s[32:33], v[60:61]
    v_pk_mul_f32 v[70:71], s[32:33], v[62:63]
    v_pk_mul_f32 v[72:73], s[32:33], v[64:65]
    v_lshlrev_b32 v52, 16, v48
    v_and_b32 v53, 0xffff0000, v48
    v_lshlrev_b32 v54, 16, v49
    v_and_b32 v55, 0xffff0000, v49
    v_lshlrev_b32 v56, 16, v50
    v_and_b32 v57, 0xffff0000, v50
    v_pk_fma_f32 v[66:67], s[34:35], v[56:57], v[66:67]
    v_pk_fma_f32 v[68:69], s[34:35], v[58:59], v[68:69]
    v_pk_fma_f32 v[70:71], s[34:35], v[60:61], v[70:71]
    v_pk_fma_f32 v[72:73], s[34:35], v[62:63], v[72:73]
    v_pk_fma_f32 v[66:67], s[36:37], v[54:55], v[66:67]
    v_pk_fma_f32 v[68:69], s[36:37], v[56:57], v[68:69]
    v_pk_fma_f32 v[70:71], s[36:37], v[58:59], v[70:71]
    v_pk_fma_f32 v[72:73], s[36:37], v[60:61], v[72:73]
    v_pk_fma_f32 v[66:67], s[38:39], v[52:53], v[66:67]
    v_pk_fma_f32 v[68:69], s[38:39], v[54:55], v[68:69]
    v_pk_fma_f32 v[70:71], s[38:39], v[56:57], v[70:71]
    v_pk_fma_f32 v[72:73], s[38:39], v[58:59], v[72:73]
    v_lshlrev_b32 v52, 16, v32
    v_and_b32 v53, 0xffff0000, v32
    v_lshlrev_b32 v54, 16, v36
    v_and_b32 v55, 0xffff0000, v36
    v_lshlrev_b32 v56, 16, v40
    v_and_b32 v57, 0xffff0000, v40
    v_lshlrev_b32 v58, 16, v44
    v_and_b32 v59, 0xffff0000, v44
    v_pk_mul_f32 v[66:67], v[66:67], v[52:53]
    v_pk_mul_f32 v[68:69], v[68:69], v[54:55]
    v_pk_mul_f32 v[70:71], v[70:71], v[56:57]
    v_pk_mul_f32 v[72:73], v[72:73], v[58:59]
    v_cvt_pk_bf16_f32 v60, v72, v70
    v_cvt_pk_bf16_f32 v61, v68, v66
    ds_write_b64 v4, v[60:61] offset:0
    v_cvt_pk_bf16_f32 v62, v73, v71
    v_cvt_pk_bf16_f32 v63, v69, v67
    ds_write_b64 v4, v[62:63] offset:4608
    v_mov_b32 v48, s85
    v_mov_b32 v49, s89
    v_mov_b32 v50, s93
    v_lshlrev_b32 v58, 16, v17
    v_and_b32 v59, 0xffff0000, v17
    v_lshlrev_b32 v60, 16, v21
    v_and_b32 v61, 0xffff0000, v21
    v_lshlrev_b32 v62, 16, v25
    v_and_b32 v63, 0xffff0000, v25
    v_lshlrev_b32 v64, 16, v29
    v_and_b32 v65, 0xffff0000, v29
    v_mov_b32_dpp v48, v21 wave_shr:1 row_mask:0xf bank_mask:0xf
    v_mov_b32_dpp v49, v25 wave_shr:1 row_mask:0xf bank_mask:0xf
    v_mov_b32_dpp v50, v29 wave_shr:1 row_mask:0xf bank_mask:0xf
    v_pk_mul_f32 v[66:67], s[40:41], v[58:59]
    v_pk_mul_f32 v[68:69], s[40:41], v[60:61]
    v_pk_mul_f32 v[70:71], s[40:41], v[62:63]
    v_pk_mul_f32 v[72:73], s[40:41], v[64:65]
    v_lshlrev_b32 v52, 16, v48
    v_and_b32 v53, 0xffff0000, v48
    v_lshlrev_b32 v54, 16, v49
    v_and_b32 v55, 0xffff0000, v49
    v_lshlrev_b32 v56, 16, v50
    v_and_b32 v57, 0xffff0000, v50
    v_pk_fma_f32 v[66:67], s[42:43], v[56:57], v[66:67]
    v_pk_fma_f32 v[68:69], s[42:43], v[58:59], v[68:69]
    v_pk_fma_f32 v[70:71], s[42:43], v[60:61], v[70:71]
    v_pk_fma_f32 v[72:73], s[42:43], v[62:63], v[72:73]
    v_pk_fma_f32 v[66:67], s[44:45], v[54:55], v[66:67]
    v_pk_fma_f32 v[68:69], s[44:45], v[56:57], v[68:69]
    v_pk_fma_f32 v[70:71], s[44:45], v[58:59], v[70:71]
    v_pk_fma_f32 v[72:73], s[44:45], v[60:61], v[72:73]
    v_pk_fma_f32 v[66:67], s[46:47], v[52:53], v[66:67]
    v_pk_fma_f32 v[68:69], s[46:47], v[54:55], v[68:69]
    v_pk_fma_f32 v[70:71], s[46:47], v[56:57], v[70:71]
    v_pk_fma_f32 v[72:73], s[46:47], v[58:59], v[72:73]
    v_lshlrev_b32 v52, 16, v33
    v_and_b32 v53, 0xffff0000, v33
    v_lshlrev_b32 v54, 16, v37
    v_and_b32 v55, 0xffff0000, v37
    v_lshlrev_b32 v56, 16, v41
    v_and_b32 v57, 0xffff0000, v41
    v_lshlrev_b32 v58, 16, v45
    v_and_b32 v59, 0xffff0000, v45
    v_pk_mul_f32 v[66:67], v[66:67], v[52:53]
    v_pk_mul_f32 v[68:69], v[68:69], v[54:55]
    v_pk_mul_f32 v[70:71], v[70:71], v[56:57]
    v_pk_mul_f32 v[72:73], v[72:73], v[58:59]
    v_cvt_pk_bf16_f32 v60, v72, v70
    v_cvt_pk_bf16_f32 v61, v68, v66
    ds_write_b64 v4, v[60:61] offset:9216
    v_cvt_pk_bf16_f32 v62, v73, v71
    v_cvt_pk_bf16_f32 v63, v69, v67
    ds_write_b64 v4, v[62:63] offset:13824
    v_mov_b32 v48, s86
    v_mov_b32 v49, s90
    v_mov_b32 v50, s94
    v_lshlrev_b32 v58, 16, v18
    v_and_b32 v59, 0xffff0000, v18
    v_lshlrev_b32 v60, 16, v22
    v_and_b32 v61, 0xffff0000, v22
    v_lshlrev_b32 v62, 16, v26
    v_and_b32 v63, 0xffff0000, v26
    v_lshlrev_b32 v64, 16, v30
    v_and_b32 v65, 0xffff0000, v30
    v_mov_b32_dpp v48, v22 wave_shr:1 row_mask:0xf bank_mask:0xf
    v_mov_b32_dpp v49, v26 wave_shr:1 row_mask:0xf bank_mask:0xf
    v_mov_b32_dpp v50, v30 wave_shr:1 row_mask:0xf bank_mask:0xf
    v_pk_mul_f32 v[66:67], s[48:49], v[58:59]
    v_pk_mul_f32 v[68:69], s[48:49], v[60:61]
    v_pk_mul_f32 v[70:71], s[48:49], v[62:63]
    v_pk_mul_f32 v[72:73], s[48:49], v[64:65]
    v_lshlrev_b32 v52, 16, v48
    v_and_b32 v53, 0xffff0000, v48
    v_lshlrev_b32 v54, 16, v49
    v_and_b32 v55, 0xffff0000, v49
    v_lshlrev_b32 v56, 16, v50
    v_and_b32 v57, 0xffff0000, v50
    v_pk_fma_f32 v[66:67], s[50:51], v[56:57], v[66:67]
    v_pk_fma_f32 v[68:69], s[50:51], v[58:59], v[68:69]
    v_pk_fma_f32 v[70:71], s[50:51], v[60:61], v[70:71]
    v_pk_fma_f32 v[72:73], s[50:51], v[62:63], v[72:73]
    v_pk_fma_f32 v[66:67], s[52:53], v[54:55], v[66:67]
    v_pk_fma_f32 v[68:69], s[52:53], v[56:57], v[68:69]
    v_pk_fma_f32 v[70:71], s[52:53], v[58:59], v[70:71]
    v_pk_fma_f32 v[72:73], s[52:53], v[60:61], v[72:73]
    v_pk_fma_f32 v[66:67], s[54:55], v[52:53], v[66:67]
    v_pk_fma_f32 v[68:69], s[54:55], v[54:55], v[68:69]
    v_pk_fma_f32 v[70:71], s[54:55], v[56:57], v[70:71]
    v_pk_fma_f32 v[72:73], s[54:55], v[58:59], v[72:73]
    v_lshlrev_b32 v52, 16, v34
    v_and_b32 v53, 0xffff0000, v34
    v_lshlrev_b32 v54, 16, v38
    v_and_b32 v55, 0xffff0000, v38
    v_lshlrev_b32 v56, 16, v42
    v_and_b32 v57, 0xffff0000, v42
    v_lshlrev_b32 v58, 16, v46
    v_and_b32 v59, 0xffff0000, v46
    v_pk_mul_f32 v[66:67], v[66:67], v[52:53]
    v_pk_mul_f32 v[68:69], v[68:69], v[54:55]
    v_pk_mul_f32 v[70:71], v[70:71], v[56:57]
    v_pk_mul_f32 v[72:73], v[72:73], v[58:59]
    v_cvt_pk_bf16_f32 v60, v72, v70
    v_cvt_pk_bf16_f32 v61, v68, v66
    ds_write_b64 v4, v[60:61] offset:18432
    v_cvt_pk_bf16_f32 v62, v73, v71
    v_cvt_pk_bf16_f32 v63, v69, v67
    ds_write_b64 v4, v[62:63] offset:23040
    v_mov_b32 v48, s87
    v_mov_b32 v49, s91
    v_mov_b32 v50, s95
    v_lshlrev_b32 v58, 16, v19
    v_and_b32 v59, 0xffff0000, v19
    v_lshlrev_b32 v60, 16, v23
    v_and_b32 v61, 0xffff0000, v23
    v_lshlrev_b32 v62, 16, v27
    v_and_b32 v63, 0xffff0000, v27
    v_lshlrev_b32 v64, 16, v31
    v_and_b32 v65, 0xffff0000, v31
    v_mov_b32_dpp v48, v23 wave_shr:1 row_mask:0xf bank_mask:0xf
    v_mov_b32_dpp v49, v27 wave_shr:1 row_mask:0xf bank_mask:0xf
    v_mov_b32_dpp v50, v31 wave_shr:1 row_mask:0xf bank_mask:0xf
    v_pk_mul_f32 v[66:67], s[56:57], v[58:59]
    v_pk_mul_f32 v[68:69], s[56:57], v[60:61]
    v_pk_mul_f32 v[70:71], s[56:57], v[62:63]
    v_pk_mul_f32 v[72:73], s[56:57], v[64:65]
    v_lshlrev_b32 v52, 16, v48
    v_and_b32 v53, 0xffff0000, v48
    v_lshlrev_b32 v54, 16, v49
    v_and_b32 v55, 0xffff0000, v49
    v_lshlrev_b32 v56, 16, v50
    v_and_b32 v57, 0xffff0000, v50
    v_pk_fma_f32 v[66:67], s[58:59], v[56:57], v[66:67]
    v_pk_fma_f32 v[68:69], s[58:59], v[58:59], v[68:69]
    v_pk_fma_f32 v[70:71], s[58:59], v[60:61], v[70:71]
    v_pk_fma_f32 v[72:73], s[58:59], v[62:63], v[72:73]
    v_pk_fma_f32 v[66:67], s[60:61], v[54:55], v[66:67]
    v_pk_fma_f32 v[68:69], s[60:61], v[56:57], v[68:69]
    v_pk_fma_f32 v[70:71], s[60:61], v[58:59], v[70:71]
    v_pk_fma_f32 v[72:73], s[60:61], v[60:61], v[72:73]
    v_pk_fma_f32 v[66:67], s[62:63], v[52:53], v[66:67]
    v_pk_fma_f32 v[68:69], s[62:63], v[54:55], v[68:69]
    v_pk_fma_f32 v[70:71], s[62:63], v[56:57], v[70:71]
    v_pk_fma_f32 v[72:73], s[62:63], v[58:59], v[72:73]
    v_lshlrev_b32 v52, 16, v35
    v_and_b32 v53, 0xffff0000, v35
    v_lshlrev_b32 v54, 16, v39
    v_and_b32 v55, 0xffff0000, v39
    v_lshlrev_b32 v56, 16, v43
    v_and_b32 v57, 0xffff0000, v43
    v_lshlrev_b32 v58, 16, v47
    v_and_b32 v59, 0xffff0000, v47
    v_pk_mul_f32 v[66:67], v[66:67], v[52:53]
    v_pk_mul_f32 v[68:69], v[68:69], v[54:55]
    v_pk_mul_f32 v[70:71], v[70:71], v[56:57]
    v_pk_mul_f32 v[72:73], v[72:73], v[58:59]
    v_cvt_pk_bf16_f32 v60, v72, v70
    v_cvt_pk_bf16_f32 v61, v68, v66
    ds_write_b64 v4, v[60:61] offset:27648
    v_cvt_pk_bf16_f32 v62, v73, v71
    v_cvt_pk_bf16_f32 v63, v69, v67
    ds_write_b64 v4, v[62:63] offset:32256
    ds_write_b32 v7, v14 offset:0
    s_cmp_ge_u32 s4, 2
    s_cbranch_scc1 L_A_nostage2
    v_add_u32 v9, s28, v10
    v_readlane_b32 s64, v96, 0
    v_readlane_b32 s65, v97, 0
    v_readlane_b32 s66, v100, 0
    v_readlane_b32 s67, v101, 0
    v_readlane_b32 s68, v104, 0
    v_readlane_b32 s69, v105, 0
    v_readlane_b32 s70, v108, 0
    v_readlane_b32 s71, v109, 0
    v_alignbit_b32 v112, v97, v96, 16
    v_alignbit_b32 v113, v98, v97, 16
    v_alignbit_b32 v114, v99, v98, 16
    v_alignbit_b32 v116, v101, v100, 16
    v_alignbit_b32 v117, v102, v101, 16
    v_alignbit_b32 v118, v103, v102, 16
    v_alignbit_b32 v120, v105, v104, 16
    v_alignbit_b32 v121, v106, v105, 16
    v_alignbit_b32 v122, v107, v106, 16
    v_alignbit_b32 v124, v109, v108, 16
    v_alignbit_b32 v125, v110, v109, 16
    v_alignbit_b32 v126, v111, v110, 16
    v_mov_b32 v64, s66
    v_mov_b32 v65, s67
    v_mov_b32 v66, s68
    v_mov_b32 v67, s69
    v_mov_b32 v68, s70
    v_mov_b32 v69, s71
    v_mov_b32 v70, s70
    v_mov_b32 v71, s71
    s_nop 0
    v_mov_b32_dpp v64, v96 wave_shl:1 row_mask:0xf bank_mask:0xf
    v_mov_b32_dpp v65, v97 wave_shl:1 row_mask:0xf bank_mask:0xf
    v_mov_b32_dpp v66, v100 wave_shl:1 row_mask:0xf bank_mask:0xf
    v_mov_b32_dpp v67, v101 wave_shl:1 row_mask:0xf bank_mask:0xf
    v_mov_b32_dpp v68, v104 wave_shl:1 row_mask:0xf bank_mask:0xf
    v_mov_b32_dpp v69, v105 wave_shl:1 row_mask:0xf bank_mask:0xf
    v_mov_b32_dpp v70, v108 wave_shl:1 row_mask:0xf bank_mask:0xf
    v_mov_b32_dpp v71, v109 wave_shl:1 row_mask:0xf bank_mask:0xf
    v_alignbit_b32 v115, v64, v99, 16
    v_pk_mov_b32 v[80:81], v[96:97], v[98:99] op_sel:[1,0]
    v_pk_mov_b32 v[82:83], v[98:99], v[64:65] op_sel:[1,0]
    v_alignbit_b32 v119, v66, v103, 16
    v_pk_mov_b32 v[84:85], v[100:101], v[102:103] op_sel:[1,0]
    v_pk_mov_b32 v[86:87], v[102:103], v[66:67] op_sel:[1,0]
    v_alignbit_b32 v123, v68, v107, 16
    v_pk_mov_b32 v[88:89], v[104:105], v[106:107] op_sel:[1,0]
    v_pk_mov_b32 v[90:91], v[106:107], v[68:69] op_sel:[1,0]
    v_alignbit_b32 v127, v70, v111, 16
    v_pk_mov_b32 v[92:93], v[108:109], v[110:111] op_sel:[1,0]
    v_pk_mov_b32 v[94:95], v[110:111], v[70:71] op_sel:[1,0]
    v_alignbit_b32 v64, v65, v64, 16
    v_alignbit_b32 v66, v67, v66, 16
    v_alignbit_b32 v68, v69, v68, 16
    v_alignbit_b32 v70, v71, v70, 16
    v_pk_mov_b32 v[48:49], v[112:113], v[114:115] op_sel:[1,0]
    v_pk_mov_b32 v[50:51], v[114:115], v[64:65] op_sel:[1,0]
    v_pk_mov_b32 v[52:53], v[116:117], v[118:119] op_sel:[1,0]
    v_pk_mov_b32 v[54:55], v[118:119], v[66:67] op_sel:[1,0]
    v_pk_mov_b32 v[56:57], v[120:121], v[122:123] op_sel:[1,0]
    v_pk_mov_b32 v[58:59], v[122:123], v[68:69] op_sel:[1,0]
    v_pk_mov_b32 v[60:61], v[124:125], v[126:127] op_sel:[1,0]
    v_pk_mov_b32 v[62:63], v[126:127], v[70:71] op_sel:[1,0]
    ds_write_b128 v9, v[104:107] offset:32
    ds_write_b128 v9, v[120:123] offset:2144
    ds_write_b128 v9, v[88:91] offset:4256
    ds_write_b128 v9, v[56:59] offset:6368
    ds_write_b128 v9, v[108:111] offset:1056
    ds_write_b128 v9, v[124:127] offset:3168
    ds_write_b128 v9, v[92:95] offset:5280
    ds_write_b128 v9, v[60:63] offset:7392
    v_subrev_u32 v72, 992, v9
    s_mov_b32 exec_lo, 0
    s_mov_b32 exec_hi, 0xc0000000
    ds_write_b128 v72, v[100:103] offset:0
    ds_write_b128 v72, v[116:119] offset:2112
    ds_write_b128 v72, v[84:87] offset:4224
    ds_write_b128 v72, v[52:55] offset:6336
    s_mov_b64 exec, -1
    ds_read_b64 v[128:129], v8 offset:1536
    ds_read_b64 v[130:131], v8 offset:1544
    ds_read_b64 v[160:161], v8 offset:1024
    ds_read_b64 v[162:163], v8 offset:1032
    ds_read_b64 v[192:193], v8 offset:512
    ds_read_b64 v[194:195], v8 offset:520
    ds_read_b64 v[224:225], v8 offset:0
    ds_read_b64 v[226:227], v8 offset:8
    ds_read_b64 v[132:133], v8 offset:1600
    ds_read_b64 v[134:135], v8 offset:1608
    ds_read_b64 v[164:165], v8 offset:1088
    ds_read_b64 v[166:167], v8 offset:1096
    ds_read_b64 v[196:197], v8 offset:576
    ds_read_b64 v[198:199], v8 offset:584
    ds_read_b64 v[228:229], v8 offset:64
    ds_read_b64 v[230:231], v8 offset:72
    ds_read_b64 v[136:137], v8 offset:1664
    ds_read_b64 v[138:139], v8 offset:1672
    ds_read_b64 v[168:169], v8 offset:1152
    ds_read_b64 v[170:171], v8 offset:1160
    ds_read_b64 v[200:201], v8 offset:640
    ds_read_b64 v[202:203], v8 offset:648
    ds_read_b64 v[232:233], v8 offset:128
    ds_read_b64 v[234:235], v8 offset:136
    ds_read_b64 v[140:141], v8 offset:1728
    ds_read_b64 v[142:143], v8 offset:1736
    ds_read_b64 v[172:173], v8 offset:1216
    ds_read_b64 v[174:175], v8 offset:1224
    ds_read_b64 v[204:205], v8 offset:704
    ds_read_b64 v[206:207], v8 offset:712
    ds_read_b64 v[236:237], v8 offset:192
    ds_read_b64 v[238:239], v8 offset:200
    ds_read_b64 v[144:145], v8 offset:1792
    ds_read_b64 v[146:147], v8 offset:1800
    ds_read_b64 v[176:177], v8 offset:1280
    ds_read_b64 v[178:179], v8 offset:1288
    ds_read_b64 v[208:209], v8 offset:768
    ds_read_b64 v[210:211], v8 offset:776
    ds_read_b64 v[240:241], v8 offset:256
    ds_read_b64 v[242:243], v8 offset:264
    ds_read_b64 v[148:149], v8 offset:1856
    ds_read_b64 v[150:151], v8 offset:1864
    ds_read_b64 v[180:181], v8 offset:1344
    ds_read_b64 v[182:183], v8 offset:1352
    ds_read_b64 v[212:213], v8 offset:832
    ds_read_b64 v[214:215], v8 offset:840
    ds_read_b64 v[244:245], v8 offset:320
    ds_read_b64 v[246:247], v8 offset:328
    ds_read_b64 v[152:153], v8 offset:1920
    ds_read_b64 v[154:155], v8 offset:1928
    ds_read_b64 v[184:185], v8 offset:1408
    ds_read_b64 v[186:187], v8 offset:1416
    ds_read_b64 v[216:217], v8 offset:896
    ds_read_b64 v[218:219], v8 offset:904
    ds_read_b64 v[248:249], v8 offset:384
    ds_read_b64 v[250:251], v8 offset:392
    ds_read_b64 v[156:157], v8 offset:1984
    ds_read_b64 v[158:159], v8 offset:1992
    ds_read_b64 v[188:189], v8 offset:1472
    ds_read_b64 v[190:191], v8 offset:1480
    ds_read_b64 v[220:221], v8 offset:960
    ds_read_b64 v[222:223], v8 offset:968
    ds_read_b64 v[252:253], v8 offset:448
    ds_read_b64 v[254:255], v8 offset:456
    ds_write_b128 v9, v[96:99] offset:32
    ds_write_b128 v9, v[112:115] offset:2144
    ds_write_b128 v9, v[80:83] offset:4256
    ds_write_b128 v9, v[48:51] offset:6368
    ds_write_b128 v9, v[100:103] offset:1056
    ds_write_b128 v9, v[116:119] offset:3168
    ds_write_b128 v9, v[84:87] offset:5280
    ds_write_b128 v9, v[52:55] offset:7392
    v_lshlrev_b32 v9, 2, v1
    v_add_u32 v9, s28, v9
    v_readlane_b32 s30, v96, 0
    v_readlane_b32 s31, v112, 0
    v_mov_b32 v64, 0
    v_mov_b32 v65, 0
    v_mov_b32 v66, 0
    v_mov_b32 v67, 0
    s_lshl_b32 s5, s30, 16
    v_writelane_b32 v65, s5, 7
    v_writelane_b32 v66, s30, 7
    v_writelane_b32 v67, s5, 6
    v_writelane_b32 v67, s31, 7
    s_mov_b64 exec, 0xff
    ds_write_b32 v9, v64 offset:0
    ds_write_b32 v9, v65 offset:2112
    ds_write_b32 v9, v66 offset:4224
    ds_write_b32 v9, v67 offset:6336
    s_mov_b64 exec, -1
L_A_nostage2:
    s_waitcnt lgkmcnt(0)
    s_bitcmp1_b32 s97, 0
    s_cbranch_scc0 L_spin_2
L_ok_1:
    ds_read_b128 v[80:83], v12 offset:3584
    ds_read_b128 v[84:87], v12 offset:3648
    ds_read_b128 v[88:91], v12 offset:3712
    ds_read_b128 v[92:95], v12 offset:3776
    s_waitcnt lgkmcnt(3)
    v_mfma_f32_16x16x32_bf16 v[124:127], v[128:131], v[80:83], 0
    ds_read_b64 v[128:129], v8 offset:1536
    ds_read_b64 v[130:131], v8 offset:1544
    v_mfma_f32_16x16x32_bf16 v[120:123], v[160:163], v[80:83], 0
    v_mfma_f32_16x16x32_bf16 v[116:119], v[192:195], v[80:83], 0
    v_mfma_f32_16x16x32_bf16 v[112:115], v[224:227], v[80:83], 0
    ds_read_b128 v[80:83], v12 offset:3840
    s_waitcnt lgkmcnt(5)
    v_mfma_f32_16x16x32_bf16 v[124:127], v[132:135], v[84:87], v[124:127]
    ds_read_b64 v[132:133], v8 offset:1600
    ds_read_b64 v[134:135], v8 offset:1608
    v_mfma_f32_16x16x32_bf16 v[120:123], v[164:167], v[84:87], v[120:123]
    v_mfma_f32_16x16x32_bf16 v[116:119], v[196:199], v[84:87], v[116:119]
    v_mfma_f32_16x16x32_bf16 v[112:115], v[228:231], v[84:87], v[112:115]
    ds_read_b128 v[84:87], v12 offset:3904
    s_waitcnt lgkmcnt(7)
    v_mfma_f32_16x16x32_bf16 v[124:127], v[136:139], v[88:91], v[124:127]
    ds_read_b64 v[136:137], v8 offset:1664
    ds_read_b64 v[138:139], v8 offset:1672
    v_mfma_f32_16x16x32_bf16 v[120:123], v[168:171], v[88:91], v[120:123]
    v_mfma_f32_16x16x32_bf16 v[116:119], v[200:203], v[88:91], v[116:119]
    v_mfma_f32_16x16x32_bf16 v[112:115], v[232:235], v[88:91], v[112:115]
    ds_read_b128 v[88:91], v12 offset:3968
    s_waitcnt lgkmcnt(9)
    v_mfma_f32_16x16x32_bf16 v[124:127], v[140:143], v[92:95], v[124:127]
    ds_read_b64 v[140:141], v8 offset:1728
    ds_read_b64 v[142:143], v8 offset:1736
    v_mfma_f32_16x16x32_bf16 v[120:123], v[172:175], v[92:95], v[120:123]
    v_mfma_f32_16x16x32_bf16 v[116:119], v[204:207], v[92:95], v[116:119]
    v_mfma_f32_16x16x32_bf16 v[112:115], v[236:239], v[92:95], v[112:115]
    ds_read_b128 v[92:95], v12 offset:4032
    s_waitcnt lgkmcnt(9)
    v_mfma_f32_16x16x32_bf16 v[124:127], v[144:147], v[80:83], v[124:127]
    ds_read_b64 v[144:145], v8 offset:1792
    ds_read_b64 v[146:147], v8 offset:1800
    v_mfma_f32_16x16x32_bf16 v[120:123], v[176:179], v[80:83], v[120:123]
    v_mfma_f32_16x16x32_bf16 v[116:119], v[208:211], v[80:83], v[116:119]
    v_mfma_f32_16x16x32_bf16 v[112:115], v[240:243], v[80:83], v[112:115]
    s_bitcmp1_b32 s97, 1
    s_cbranch_scc0 L_spin_4
L_ok_3:
    ds_read_b128 v[80:83], v12 offset:3072
    s_waitcnt lgkmcnt(9)
    v_mfma_f32_16x16x32_bf16 v[124:127], v[148:151], v[84:87], v[124:127]
    ds_read_b64 v[148:149], v8 offset:1856
    ds_read_b64 v[150:151], v8 offset:1864
    v_mfma_f32_16x16x32_bf16 v[120:123], v[180:183], v[84:87], v[120:123]
    v_mfma_f32_16x16x32_bf16 v[116:119], v[212:215], v[84:87], v[116:119]
    v_mfma_f32_16x16x32_bf16 v[112:115], v[244:247], v[84:87], v[112:115]
    ds_read_b128 v[84:87], v12 offset:3136
    s_waitcnt lgkmcnt(9)
    v_mfma_f32_16x16x32_bf16 v[124:127], v[152:155], v[88:91], v[124:127]
    ds_read_b64 v[152:153], v8 offset:1920
    ds_read_b64 v[154:155], v8 offset:1928
    v_mfma_f32_16x16x32_bf16 v[120:123], v[184:187], v[88:91], v[120:123]
    v_mfma_f32_16x16x32_bf16 v[116:119], v[216:219], v[88:91], v[116:119]
    v_mfma_f32_16x16x32_bf16 v[112:115], v[248:251], v[88:91], v[112:115]
    ds_read_b128 v[88:91], v12 offset:3200
    s_waitcnt lgkmcnt(9)
    v_mfma_f32_16x16x32_bf16 v[124:127], v[156:159], v[92:95], v[124:127]
    ds_read_b64 v[156:157], v8 offset:1984
    ds_read_b64 v[158:159], v8 offset:1992
    v_mfma_f32_16x16x32_bf16 v[120:123], v[188:191], v[92:95], v[120:123]
    v_mfma_f32_16x16x32_bf16 v[116:119], v[220:223], v[92:95], v[116:119]
    v_mfma_f32_16x16x32_bf16 v[112:115], v[252:255], v[92:95], v[112:115]
    ds_read_b128 v[92:95], v12 offset:3264
    ds_read_b128 v[32:35], v12 offset:3328
    ds_read_b128 v[36:39], v12 offset:3392
    ds_read_b128 v[40:43], v12 offset:3456
    ds_read_b128 v[44:47], v12 offset:3520
    s_waitcnt lgkmcnt(13)
    v_mfma_f32_16x16x32_bf16 v[124:127], v[160:163], v[80:83], v[124:127]
    ds_read_b64 v[160:161], v8 offset:1024
    ds_read_b64 v[162:163], v8 offset:1032
    v_mfma_f32_16x16x32_bf16 v[120:123], v[192:195], v[80:83], v[120:123]
    v_mfma_f32_16x16x32_bf16 v[116:119], v[224:227], v[80:83], v[116:119]
    v_mfma_f32_16x16x32_bf16 v[112:115], v[128:131], v[80:83], v[112:115]
    s_bitcmp1_b32 s97, 2
    s_cbranch_scc0 L_spin_6
L_ok_5:
    ds_read_b128 v[48:51], v12 offset:2560
    ds_read_b128 v[52:55], v12 offset:2624
    ds_read_b128 v[56:59], v12 offset:2688
    ds_read_b128 v[60:63], v12 offset:2752
    s_waitcnt lgkmcnt(15)
    v_mfma_f32_16x16x32_bf16 v[124:127], v[164:167], v[84:87], v[124:127]
    ds_read_b64 v[164:165], v8 offset:1088
    ds_read_b64 v[166:167], v8 offset:1096
    v_mfma_f32_16x16x32_bf16 v[120:123], v[196:199], v[84:87], v[120:123]
    v_mfma_f32_16x16x32_bf16 v[116:119], v[228:231], v[84:87], v[116:119]
    v_mfma_f32_16x16x32_bf16 v[112:115], v[132:135], v[84:87], v[112:115]
    ds_read_b128 v[80:83], v12 offset:2816
    s_waitcnt lgkmcnt(15)
    v_mfma_f32_16x16x32_bf16 v[124:127], v[168:171], v[88:91], v[124:127]
    ds_read_b64 v[168:169], v8 offset:1152
    ds_read_b64 v[170:171], v8 offset:1160
    v_mfma_f32_16x16x32_bf16 v[120:123], v[200:203], v[88:91], v[120:123]
    v_mfma_f32_16x16x32_bf16 v[116:119], v[232:235], v[88:91], v[116:119]
    v_mfma_f32_16x16x32_bf16 v[112:115], v[136:139], v[88:91], v[112:115]
    ds_read_b128 v[84:87], v12 offset:2880
    s_waitcnt lgkmcnt(15)
    v_mfma_f32_16x16x32_bf16 v[124:127], v[172:175], v[92:95], v[124:127]
    ds_read_b64 v[172:173], v8 offset:1216
    ds_read_b64 v[174:175], v8 offset:1224
    v_mfma_f32_16x16x32_bf16 v[120:123], v[204:207], v[92:95], v[120:123]
    v_mfma_f32_16x16x32_bf16 v[116:119], v[236:239], v[92:95], v[116:119]
    v_mfma_f32_16x16x32_bf16 v[112:115], v[140:143], v[92:95], v[112:115]
    ds_read_b128 v[88:91], v12 offset:2944
    v_mfma_f32_16x16x32_bf16 v[124:127], v[176:179], v[32:35], v[124:127]
    ds_read_b64 v[176:177], v8 offset:1280
    ds_read_b64 v[178:179], v8 offset:1288
    v_mfma_f32_16x16x32_bf16 v[120:123], v[208:211], v[32:35], v[120:123]
    v_mfma_f32_16x16x32_bf16 v[116:119], v[240:243], v[32:35], v[116:119]
    v_mfma_f32_16x16x32_bf16 v[112:115], v[144:147], v[32:35], v[112:115]
    ds_read_b128 v[92:95], v12 offset:3008
    s_waitcnt lgkmcnt(15)
    v_mfma_f32_16x16x32_bf16 v[124:127], v[180:183], v[36:39], v[124:127]
    ds_read_b64 v[180:181], v8 offset:1344
    ds_read_b64 v[182:183], v8 offset:1352
    v_mfma_f32_16x16x32_bf16 v[120:123], v[212:215], v[36:39], v[120:123]
    v_mfma_f32_16x16x32_bf16 v[116:119], v[244:247], v[36:39], v[116:119]
    v_mfma_f32_16x16x32_bf16 v[112:115], v[148:151], v[36:39], v[112:115]
    v_mfma_f32_16x16x32_bf16 v[124:127], v[184:187], v[40:43], v[124:127]
    ds_read_b64 v[184:185], v8 offset:1408
    ds_read_b64 v[186:187], v8 offset:1416
    v_mfma_f32_16x16x32_bf16 v[120:123], v[216:219], v[40:43], v[120:123]
    v_mfma_f32_16x16x32_bf16 v[116:119], v[248:251], v[40:43], v[116:119]
    v_mfma_f32_16x16x32_bf16 v[112:115], v[152:155], v[40:43], v[112:115]
    v_mfma_f32_16x16x32_bf16 v[124:127], v[188:191], v[44:47], v[124:127]
    ds_read_b64 v[188:189], v8 offset:1472
    ds_read_b64 v[190:191], v8 offset:1480
    v_mfma_f32_16x16x32_bf16 v[120:123], v[220:223], v[44:47], v[120:123]
    v_mfma_f32_16x16x32_bf16 v[116:119], v[252:255], v[44:47], v[116:119]
    v_mfma_f32_16x16x32_bf16 v[112:115], v[156:159], v[44:47], v[112:115]
    s_bitcmp1_b32 s97, 3
    s_cbranch_scc0 L_spin_8
L_ok_7:
    ds_read_b128 v[32:35], v12 offset:2048
    ds_read_b128 v[36:39], v12 offset:2112
    ds_read_b128 v[40:43], v12 offset:2176
    v_mfma_f32_16x16x32_bf16 v[124:127], v[192:195], v[48:51], v[124:127]
    ds_read_b64 v[192:193], v8 offset:512
    ds_read_b64 v[194:195], v8 offset:520
    v_mfma_f32_16x16x32_bf16 v[120:123], v[224:227], v[48:51], v[120:123]
    v_mfma_f32_16x16x32_bf16 v[116:119], v[128:131], v[48:51], v[116:119]
    v_mfma_f32_16x16x32_bf16 v[112:115], v[160:163], v[48:51], v[112:115]
    ds_read_b128 v[44:47], v12 offset:2240
    s_waitcnt lgkmcnt(15)
    v_mfma_f32_16x16x32_bf16 v[124:127], v[196:199], v[52:55], v[124:127]
    ds_read_b64 v[196:197], v8 offset:576
    ds_read_b64 v[198:199], v8 offset:584
    v_mfma_f32_16x16x32_bf16 v[120:123], v[228:231], v[52:55], v[120:123]
    v_mfma_f32_16x16x32_bf16 v[116:119], v[132:135], v[52:55], v[116:119]
    v_mfma_f32_16x16x32_bf16 v[112:115], v[164:167], v[52:55], v[112:115]
    ds_read_b128 v[48:51], v12 offset:2304
    v_mfma_f32_16x16x32_bf16 v[124:127], v[200:203], v[56:59], v[124:127]
    ds_read_b64 v[200:201], v8 offset:640
    ds_read_b64 v[202:203], v8 offset:648
    v_mfma_f32_16x16x32_bf16 v[120:123], v[232:235], v[56:59], v[120:123]
    v_mfma_f32_16x16x32_bf16 v[116:119], v[136:139], v[56:59], v[116:119]
    v_mfma_f32_16x16x32_bf16 v[112:115], v[168:171], v[56:59], v[112:115]
    ds_read_b128 v[52:55], v12 offset:2368
    v_mfma_f32_16x16x32_bf16 v[124:127], v[204:207], v[60:63], v[124:127]
    ds_read_b64 v[204:205], v8 offset:704
    ds_read_b64 v[206:207], v8 offset:712
    v_mfma_f32_16x16x32_bf16 v[120:123], v[236:239], v[60:63], v[120:123]
    v_mfma_f32_16x16x32_bf16 v[116:119], v[140:143], v[60:63], v[116:119]
    v_mfma_f32_16x16x32_bf16 v[112:115], v[172:175], v[60:63], v[112:115]
    ds_read_b128 v[56:59], v12 offset:2432
    v_mfma_f32_16x16x32_bf16 v[124:127], v[208:211], v[80:83], v[124:127]
    ds_read_b64 v[208:209], v8 offset:768
    ds_read_b64 v[210:211], v8 offset:776
    v_mfma_f32_16x16x32_bf16 v[120:123], v[240:243], v[80:83], v[120:123]
    v_mfma_f32_16x16x32_bf16 v[116:119], v[144:147], v[80:83], v[116:119]
    s_waitcnt lgkmcnt(15)
    v_mfma_f32_16x16x32_bf16 v[112:115], v[176:179], v[80:83], v[112:115]
    ds_read_b128 v[60:63], v12 offset:2496
    v_mfma_f32_16x16x32_bf16 v[124:127], v[212:215], v[84:87], v[124:127]
    ds_read_b64 v[212:213], v8 offset:832
    ds_read_b64 v[214:215], v8 offset:840
    v_mfma_f32_16x16x32_bf16 v[120:123], v[244:247], v[84:87], v[120:123]
    v_mfma_f32_16x16x32_bf16 v[116:119], v[148:151], v[84:87], v[116:119]
    v_mfma_f32_16x16x32_bf16 v[112:115], v[180:183], v[84:87], v[112:115]
    ds_read_b128 v[80:83], v12 offset:3584
    v_mfma_f32_16x16x32_bf16 v[124:127], v[216:219], v[88:91], v[124:127]
    ds_read_b64 v[216:217], v8 offset:896
    ds_read_b64 v[218:219], v8 offset:904
    v_mfma_f32_16x16x32_bf16 v[120:123], v[248:251], v[88:91], v[120:123]
    v_mfma_f32_16x16x32_bf16 v[116:119], v[152:155], v[88:91], v[116:119]
    v_mfma_f32_16x16x32_bf16 v[112:115], v[184:187], v[88:91], v[112:115]
    ds_read_b128 v[84:87], v12 offset:3648
    v_mfma_f32_16x16x32_bf16 v[124:127], v[220:223], v[92:95], v[124:127]
    ds_read_b64 v[220:221], v8 offset:960
    ds_read_b64 v[222:223], v8 offset:968
    v_mfma_f32_16x16x32_bf16 v[120:123], v[252:255], v[92:95], v[120:123]
    v_mfma_f32_16x16x32_bf16 v[116:119], v[156:159], v[92:95], v[116:119]
    v_mfma_f32_16x16x32_bf16 v[112:115], v[188:191], v[92:95], v[112:115]
    ds_read_b128 v[88:91], v12 offset:3712
    v_mfma_f32_16x16x32_bf16 v[124:127], v[224:227], v[32:35], v[124:127]
    ds_read_b64 v[224:225], v8 offset:0
    ds_read_b64 v[226:227], v8 offset:8
    v_mfma_f32_16x16x32_bf16 v[120:123], v[128:131], v[32:35], v[120:123]
    v_mfma_f32_16x16x32_bf16 v[116:119], v[160:163], v[32:35], v[116:119]
    s_waitcnt lgkmcnt(15)
    v_mfma_f32_16x16x32_bf16 v[112:115], v[192:195], v[32:35], v[112:115]
    ds_read_b128 v[92:95], v12 offset:3776
    v_mfma_f32_16x16x32_bf16 v[124:127], v[228:231], v[36:39], v[124:127]
    ds_read_b64 v[228:229], v8 offset:64
    ds_read_b64 v[230:231], v8 offset:72
    v_mfma_f32_16x16x32_bf16 v[120:123], v[132:135], v[36:39], v[120:123]
    v_mfma_f32_16x16x32_bf16 v[116:119], v[164:167], v[36:39], v[116:119]
    v_mfma_f32_16x16x32_bf16 v[112:115], v[196:199], v[36:39], v[112:115]
    ds_read_b128 v[32:35], v12 offset:3840
    v_mfma_f32_16x16x32_bf16 v[124:127], v[232:235], v[40:43], v[124:127]
    ds_read_b64 v[232:233], v8 offset:128
    ds_read_b64 v[234:235], v8 offset:136
    v_mfma_f32_16x16x32_bf16 v[120:123], v[136:139], v[40:43], v[120:123]
    v_mfma_f32_16x16x32_bf16 v[116:119], v[168:171], v[40:43], v[116:119]
    v_mfma_f32_16x16x32_bf16 v[112:115], v[200:203], v[40:43], v[112:115]
    ds_read_b128 v[36:39], v12 offset:3904
    v_mfma_f32_16x16x32_bf16 v[124:127], v[236:239], v[44:47], v[124:127]
    ds_read_b64 v[236:237], v8 offset:192
    ds_read_b64 v[238:239], v8 offset:200
    v_mfma_f32_16x16x32_bf16 v[120:123], v[140:143], v[44:47], v[120:123]
    v_mfma_f32_16x16x32_bf16 v[116:119], v[172:175], v[44:47], v[116:119]
    v_mfma_f32_16x16x32_bf16 v[112:115], v[204:207], v[44:47], v[112:115]
    ds_read_b128 v[40:43], v12 offset:3968
    v_mfma_f32_16x16x32_bf16 v[124:127], v[240:243], v[48:51], v[124:127]
    ds_read_b64 v[240:241], v8 offset:256
    ds_read_b64 v[242:243], v8 offset:264
    v_mfma_f32_16x16x32_bf16 v[120:123], v[144:147], v[48:51], v[120:123]
    v_mfma_f32_16x16x32_bf16 v[116:119], v[176:179], v[48:51], v[116:119]
    s_waitcnt lgkmcnt(15)
    v_mfma_f32_16x16x32_bf16 v[112:115], v[208:211], v[48:51], v[112:115]
    ds_read_b128 v[44:47], v12 offset:4032
    v_mfma_f32_16x16x32_bf16 v[124:127], v[244:247], v[52:55], v[124:127]
    ds_read_b64 v[244:245], v8 offset:320
    ds_read_b64 v[246:247], v8 offset:328
    v_mfma_f32_16x16x32_bf16 v[120:123], v[148:151], v[52:55], v[120:123]
    v_mfma_f32_16x16x32_bf16 v[116:119], v[180:183], v[52:55], v[116:119]
    v_mfma_f32_16x16x32_bf16 v[112:115], v[212:215], v[52:55], v[112:115]
    ds_read_b128 v[48:51], v12 offset:3072
    v_mfma_f32_16x16x32_bf16 v[124:127], v[248:251], v[56:59], v[124:127]
    ds_read_b64 v[248:249], v8 offset:384
    ds_read_b64 v[250:251], v8 offset:392
    v_mfma_f32_16x16x32_bf16 v[120:123], v[152:155], v[56:59], v[120:123]
    v_mfma_f32_16x16x32_bf16 v[116:119], v[184:187], v[56:59], v[116:119]
    v_mfma_f32_16x16x32_bf16 v[112:115], v[216:219], v[56:59], v[112:115]
    ds_read_b128 v[52:55], v12 offset:3136
    v_mfma_f32_16x16x32_bf16 v[124:127], v[252:255], v[60:63], v[124:127]
    ds_read_b64 v[252:253], v8 offset:448
    ds_read_b64 v[254:255], v8 offset:456
    v_mfma_f32_16x16x32_bf16 v[120:123], v[156:159], v[60:63], v[120:123]
    v_mfma_f32_16x16x32_bf16 v[116:119], v[188:191], v[60:63], v[116:119]
    v_mfma_f32_16x16x32_bf16 v[112:115], v[220:223], v[60:63], v[112:115]
    ds_read_b128 v[56:59], v12 offset:3200
    v_mfma_f32_16x16x32_bf16 v[108:111], v[128:131], v[80:83], 0
    v_mfma_f32_16x16x32_bf16 v[104:107], v[160:163], v[80:83], 0
    v_mfma_f32_16x16x32_bf16 v[100:103], v[192:195], v[80:83], 0
    s_waitcnt lgkmcnt(15)
    v_mfma_f32_16x16x32_bf16 v[96:99], v[224:227], v[80:83], 0
    v_mfma_f32_16x16x32_bf16 v[96:99], v[74:77], v[80:83], v[96:99]
    ds_read_b128 v[60:63], v12 offset:3264
    v_mfma_f32_16x16x32_bf16 v[108:111], v[132:135], v[84:87], v[108:111]
    v_mfma_f32_16x16x32_bf16 v[104:107], v[164:167], v[84:87], v[104:107]
    v_mfma_f32_16x16x32_bf16 v[100:103], v[196:199], v[84:87], v[100:103]
    v_mfma_f32_16x16x32_bf16 v[96:99], v[228:231], v[84:87], v[96:99]
    ds_read_b128 v[80:83], v12 offset:3328
    v_mfma_f32_16x16x32_bf16 v[108:111], v[136:139], v[88:91], v[108:111]
    v_mfma_f32_16x16x32_bf16 v[104:107], v[168:171], v[88:91], v[104:107]
    v_mfma_f32_16x16x32_bf16 v[100:103], v[200:203], v[88:91], v[100:103]
    v_mfma_f32_16x16x32_bf16 v[96:99], v[232:235], v[88:91], v[96:99]
    ds_read_b128 v[84:87], v12 offset:3392
    v_mfma_f32_16x16x32_bf16 v[108:111], v[140:143], v[92:95], v[108:111]
    v_mfma_f32_16x16x32_bf16 v[104:107], v[172:175], v[92:95], v[104:107]
    v_mfma_f32_16x16x32_bf16 v[100:103], v[204:207], v[92:95], v[100:103]
    s_waitcnt lgkmcnt(15)
    v_mfma_f32_16x16x32_bf16 v[96:99], v[236:239], v[92:95], v[96:99]
    ds_read_b128 v[88:91], v12 offset:3456
    v_mfma_f32_16x16x32_bf16 v[108:111], v[144:147], v[32:35], v[108:111]
    v_mfma_f32_16x16x32_bf16 v[104:107], v[176:179], v[32:35], v[104:107]
    v_mfma_f32_16x16x32_bf16 v[100:103], v[208:211], v[32:35], v[100:103]
    s_waitcnt lgkmcnt(14)
    v_mfma_f32_16x16x32_bf16 v[96:99], v[240:243], v[32:35], v[96:99]
    ds_read_b128 v[92:95], v12 offset:3520
    v_mfma_f32_16x16x32_bf16 v[108:111], v[148:151], v[36:39], v[108:111]
    v_mfma_f32_16x16x32_bf16 v[104:107], v[180:183], v[36:39], v[104:107]
    v_mfma_f32_16x16x32_bf16 v[100:103], v[212:215], v[36:39], v[100:103]
    s_waitcnt lgkmcnt(12)
    v_mfma_f32_16x16x32_bf16 v[96:99], v[244:247], v[36:39], v[96:99]
    ds_read_b128 v[32:35], v12 offset:2560
    v_mfma_f32_16x16x32_bf16 v[108:111], v[152:155], v[40:43], v[108:111]
    v_mfma_f32_16x16x32_bf16 v[104:107], v[184:187], v[40:43], v[104:107]
    v_mfma_f32_16x16x32_bf16 v[100:103], v[216:219], v[40:43], v[100:103]
    s_waitcnt lgkmcnt(10)
    v_mfma_f32_16x16x32_bf16 v[96:99], v[248:251], v[40:43], v[96:99]
    ds_read_b128 v[36:39], v12 offset:2624
    v_mfma_f32_16x16x32_bf16 v[108:111], v[156:159], v[44:47], v[108:111]
    v_mfma_f32_16x16x32_bf16 v[104:107], v[188:191], v[44:47], v[104:107]
    v_mfma_f32_16x16x32_bf16 v[100:103], v[220:223], v[44:47], v[100:103]
    s_waitcnt lgkmcnt(8)
    v_mfma_f32_16x16x32_bf16 v[96:99], v[252:255], v[44:47], v[96:99]
    ds_read_b128 v[40:43], v12 offset:2688
    v_mfma_f32_16x16x32_bf16 v[108:111], v[160:163], v[48:51], v[108:111]
    v_mfma_f32_16x16x32_bf16 v[104:107], v[192:195], v[48:51], v[104:107]
    v_mfma_f32_16x16x32_bf16 v[100:103], v[224:227], v[48:51], v[100:103]
    v_mfma_f32_16x16x32_bf16 v[100:103], v[74:77], v[48:51], v[100:103]
    ds_read_b128 v[44:47], v12 offset:2752
    v_mfma_f32_16x16x32_bf16 v[108:111], v[164:167], v[52:55], v[108:111]
    v_mfma_f32_16x16x32_bf16 v[104:107], v[196:199], v[52:55], v[104:107]
    v_mfma_f32_16x16x32_bf16 v[100:103], v[228:231], v[52:55], v[100:103]
    ds_read_b128 v[48:51], v12 offset:2816
    s_waitcnt lgkmcnt(10)
    v_mfma_f32_16x16x32_bf16 v[108:111], v[168:171], v[56:59], v[108:111]
    v_mfma_f32_16x16x32_bf16 v[104:107], v[200:203], v[56:59], v[104:107]
    v_cvt_pk_bf16_f32 v78, v96, v97
    v_cvt_pk_bf16_f32 v79, v98, v99
    ds_write_b64 v5, v[78:79] offset:0
    ds_add_u32 v13, v14 offset:32
    v_mfma_f32_16x16x32_bf16 v[100:103], v[232:235], v[56:59], v[100:103]
    ds_read_b128 v[52:55], v12 offset:2880
    s_waitcnt lgkmcnt(12)
    v_mfma_f32_16x16x32_bf16 v[108:111], v[172:175], v[60:63], v[108:111]
    v_mfma_f32_16x16x32_bf16 v[104:107], v[204:207], v[60:63], v[104:107]
    v_mfma_f32_16x16x32_bf16 v[100:103], v[236:239], v[60:63], v[100:103]
    ds_read_b128 v[56:59], v12 offset:2944
    s_waitcnt lgkmcnt(12)
    v_mfma_f32_16x16x32_bf16 v[108:111], v[176:179], v[80:83], v[108:111]
    v_mfma_f32_16x16x32_bf16 v[104:107], v[208:211], v[80:83], v[104:107]
    v_mfma_f32_16x16x32_bf16 v[100:103], v[240:243], v[80:83], v[100:103]
    ds_read_b128 v[60:63], v12 offset:3008
    s_waitcnt lgkmcnt(12)
    v_mfma_f32_16x16x32_bf16 v[108:111], v[180:183], v[84:87], v[108:111]
    v_mfma_f32_16x16x32_bf16 v[104:107], v[212:215], v[84:87], v[104:107]
    v_mfma_f32_16x16x32_bf16 v[100:103], v[244:247], v[84:87], v[100:103]
    ds_read_b128 v[80:83], v12 offset:2048
    s_waitcnt lgkmcnt(12)
    v_mfma_f32_16x16x32_bf16 v[108:111], v[184:187], v[88:91], v[108:111]
    v_mfma_f32_16x16x32_bf16 v[104:107], v[216:219], v[88:91], v[104:107]
    v_mfma_f32_16x16x32_bf16 v[100:103], v[248:251], v[88:91], v[100:103]
    ds_read_b128 v[84:87], v12 offset:2112
    s_waitcnt lgkmcnt(12)
    v_mfma_f32_16x16x32_bf16 v[108:111], v[188:191], v[92:95], v[108:111]
    v_mfma_f32_16x16x32_bf16 v[104:107], v[220:223], v[92:95], v[104:107]
    v_mfma_f32_16x16x32_bf16 v[100:103], v[252:255], v[92:95], v[100:103]
    ds_read_b128 v[88:91], v12 offset:2176
    s_waitcnt lgkmcnt(12)
    v_mfma_f32_16x16x32_bf16 v[108:111], v[192:195], v[32:35], v[108:111]
    v_mfma_f32_16x16x32_bf16 v[104:107], v[224:227], v[32:35], v[104:107]
    v_mfma_f32_16x16x32_bf16 v[104:107], v[74:77], v[32:35], v[104:107]
    ds_read_b128 v[92:95], v12 offset:2240
    s_waitcnt lgkmcnt(12)
    v_mfma_f32_16x16x32_bf16 v[108:111], v[196:199], v[36:39], v[108:111]
    v_mfma_f32_16x16x32_bf16 v[104:107], v[228:231], v[36:39], v[104:107]
    ds_read_b128 v[32:35], v12 offset:2304
    s_waitcnt lgkmcnt(12)
    v_mfma_f32_16x16x32_bf16 v[108:111], v[200:203], v[40:43], v[108:111]
    v_mfma_f32_16x16x32_bf16 v[104:107], v[232:235], v[40:43], v[104:107]
    ds_read_b128 v[36:39], v12 offset:2368
    s_waitcnt lgkmcnt(12)
    v_mfma_f32_16x16x32_bf16 v[108:111], v[204:207], v[44:47], v[108:111]
    v_mfma_f32_16x16x32_bf16 v[104:107], v[236:239], v[44:47], v[104:107]
    v_cvt_pk_bf16_f32 v78, v100, v101
    v_cvt_pk_bf16_f32 v79, v102, v103
    ds_write_b64 v5, v[78:79] offset:512
    ds_add_u32 v13, v14 offset:36
    ds_read_b128 v[40:43], v12 offset:2432
    s_waitcnt lgkmcnt(14)
    v_mfma_f32_16x16x32_bf16 v[108:111], v[208:211], v[48:51], v[108:111]
    v_mfma_f32_16x16x32_bf16 v[104:107], v[240:243], v[48:51], v[104:107]
    ds_read_b128 v[44:47], v12 offset:2496
    s_waitcnt lgkmcnt(12)
    v_mfma_f32_16x16x32_bf16 v[108:111], v[212:215], v[52:55], v[108:111]
    v_mfma_f32_16x16x32_bf16 v[104:107], v[244:247], v[52:55], v[104:107]
    s_waitcnt lgkmcnt(11)
    v_mfma_f32_16x16x32_bf16 v[108:111], v[216:219], v[56:59], v[108:111]
    v_mfma_f32_16x16x32_bf16 v[104:107], v[248:251], v[56:59], v[104:107]
    s_waitcnt lgkmcnt(10)
    v_mfma_f32_16x16x32_bf16 v[108:111], v[220:223], v[60:63], v[108:111]
    v_mfma_f32_16x16x32_bf16 v[104:107], v[252:255], v[60:63], v[104:107]
    s_bitcmp1_b32 s97, 4
    s_cbranch_scc0 L_spin_10
L_ok_9:
    ds_read_b128 v[48:51], v12 offset:1536
    ds_read_b128 v[52:55], v12 offset:1600
    ds_read_b128 v[56:59], v12 offset:1664
    s_waitcnt lgkmcnt(12)
    v_mfma_f32_16x16x32_bf16 v[108:111], v[224:227], v[80:83], v[108:111]
    v_mfma_f32_16x16x32_bf16 v[108:111], v[74:77], v[80:83], v[108:111]
    ds_read_b128 v[60:63], v12 offset:1728
    s_waitcnt lgkmcnt(12)
    v_mfma_f32_16x16x32_bf16 v[108:111], v[228:231], v[84:87], v[108:111]
    ds_read_b128 v[80:83], v12 offset:1792
    s_waitcnt lgkmcnt(12)
    v_mfma_f32_16x16x32_bf16 v[108:111], v[232:235], v[88:91], v[108:111]
    ds_read_b128 v[84:87], v12 offset:1856
    s_waitcnt lgkmcnt(12)
    v_mfma_f32_16x16x32_bf16 v[108:111], v[236:239], v[92:95], v[108:111]
    ds_read_b128 v[88:91], v12 offset:1920
    s_waitcnt lgkmcnt(12)
    v_mfma_f32_16x16x32_bf16 v[108:111], v[240:243], v[32:35], v[108:111]
    ds_read_b128 v[92:95], v12 offset:1984
    s_waitcnt lgkmcnt(12)
    v_mfma_f32_16x16x32_bf16 v[108:111], v[244:247], v[36:39], v[108:111]
    s_waitcnt lgkmcnt(9)
    v_mfma_f32_16x16x32_bf16 v[108:111], v[248:251], v[40:43], v[108:111]
    s_waitcnt lgkmcnt(8)
    v_mfma_f32_16x16x32_bf16 v[108:111], v[252:255], v[44:47], v[108:111]
    v_cvt_pk_bf16_f32 v78, v104, v105
    v_cvt_pk_bf16_f32 v79, v106, v107
    ds_write_b64 v5, v[78:79] offset:1024
    ds_add_u32 v13, v14 offset:40
    s_bitcmp1_b32 s97, 5
    s_cbranch_scc0 L_spin_12
L_ok_11:
    ds_read_b128 v[32:35], v12 offset:1024
    ds_read_b128 v[36:39], v12 offset:1088
    ds_read_b128 v[40:43], v12 offset:1152
    s_waitcnt lgkmcnt(12)
    v_mfma_f32_16x16x32_bf16 v[124:127], v[128:131], v[48:51], v[124:127]
    v_mfma_f32_16x16x32_bf16 v[120:123], v[160:163], v[48:51], v[120:123]
    v_mfma_f32_16x16x32_bf16 v[116:119], v[192:195], v[48:51], v[116:119]
    v_mfma_f32_16x16x32_bf16 v[112:115], v[224:227], v[48:51], v[112:115]
    v_mfma_f32_16x16x32_bf16 v[112:115], v[74:77], v[48:51], v[112:115]
    ds_read_b128 v[44:47], v12 offset:1216
    s_waitcnt lgkmcnt(12)
    v_mfma_f32_16x16x32_bf16 v[124:127], v[132:135], v[52:55], v[124:127]
    v_mfma_f32_16x16x32_bf16 v[120:123], v[164:167], v[52:55], v[120:123]
    v_mfma_f32_16x16x32_bf16 v[116:119], v[196:199], v[52:55], v[116:119]
    v_mfma_f32_16x16x32_bf16 v[112:115], v[228:231], v[52:55], v[112:115]
    v_cvt_pk_bf16_f32 v78, v108, v109
    v_cvt_pk_bf16_f32 v79, v110, v111
    ds_write_b64 v5, v[78:79] offset:1536
    ds_add_u32 v13, v14 offset:44
    ds_read_b128 v[48:51], v12 offset:1280
    s_waitcnt lgkmcnt(14)
    v_mfma_f32_16x16x32_bf16 v[124:127], v[136:139], v[56:59], v[124:127]
    v_mfma_f32_16x16x32_bf16 v[120:123], v[168:171], v[56:59], v[120:123]
    v_mfma_f32_16x16x32_bf16 v[116:119], v[200:203], v[56:59], v[116:119]
    v_mfma_f32_16x16x32_bf16 v[112:115], v[232:235], v[56:59], v[112:115]
    ds_read_b128 v[52:55], v12 offset:1344
    s_waitcnt lgkmcnt(14)
    v_mfma_f32_16x16x32_bf16 v[124:127], v[140:143], v[60:63], v[124:127]
    v_mfma_f32_16x16x32_bf16 v[120:123], v[172:175], v[60:63], v[120:123]
    v_mfma_f32_16x16x32_bf16 v[116:119], v[204:207], v[60:63], v[116:119]
    v_mfma_f32_16x16x32_bf16 v[112:115], v[236:239], v[60:63], v[112:115]
    ds_read_b128 v[56:59], v12 offset:1408
    s_waitcnt lgkmcnt(14)
    v_mfma_f32_16x16x32_bf16 v[124:127], v[144:147], v[80:83], v[124:127]
    v_mfma_f32_16x16x32_bf16 v[120:123], v[176:179], v[80:83], v[120:123]
    v_mfma_f32_16x16x32_bf16 v[116:119], v[208:211], v[80:83], v[116:119]
    v_mfma_f32_16x16x32_bf16 v[112:115], v[240:243], v[80:83], v[112:115]
    ds_read_b128 v[60:63], v12 offset:1472
    s_waitcnt lgkmcnt(14)
    v_mfma_f32_16x16x32_bf16 v[124:127], v[148:151], v[84:87], v[124:127]
    v_mfma_f32_16x16x32_bf16 v[120:123], v[180:183], v[84:87], v[120:123]
    v_mfma_f32_16x16x32_bf16 v[116:119], v[212:215], v[84:87], v[116:119]
    v_mfma_f32_16x16x32_bf16 v[112:115], v[244:247], v[84:87], v[112:115]
    s_waitcnt lgkmcnt(13)
    v_mfma_f32_16x16x32_bf16 v[124:127], v[152:155], v[88:91], v[124:127]
    v_mfma_f32_16x16x32_bf16 v[120:123], v[184:187], v[88:91], v[120:123]
    v_mfma_f32_16x16x32_bf16 v[116:119], v[216:219], v[88:91], v[116:119]
    v_mfma_f32_16x16x32_bf16 v[112:115], v[248:251], v[88:91], v[112:115]
    s_waitcnt lgkmcnt(12)
    v_mfma_f32_16x16x32_bf16 v[124:127], v[156:159], v[92:95], v[124:127]
    v_mfma_f32_16x16x32_bf16 v[120:123], v[188:191], v[92:95], v[120:123]
    v_mfma_f32_16x16x32_bf16 v[116:119], v[220:223], v[92:95], v[116:119]
    v_mfma_f32_16x16x32_bf16 v[112:115], v[252:255], v[92:95], v[112:115]
    s_bitcmp1_b32 s97, 6
    s_cbranch_scc0 L_spin_14
L_ok_13:
    ds_read_b128 v[80:83], v12 offset:512
    ds_read_b128 v[84:87], v12 offset:576
    ds_read_b128 v[88:91], v12 offset:640
    s_waitcnt lgkmcnt(12)
    v_mfma_f32_16x16x32_bf16 v[124:127], v[160:163], v[32:35], v[124:127]
    v_mfma_f32_16x16x32_bf16 v[120:123], v[192:195], v[32:35], v[120:123]
    v_mfma_f32_16x16x32_bf16 v[116:119], v[224:227], v[32:35], v[116:119]
    v_mfma_f32_16x16x32_bf16 v[116:119], v[74:77], v[32:35], v[116:119]
    ds_read_b128 v[92:95], v12 offset:704
    s_waitcnt lgkmcnt(12)
    v_mfma_f32_16x16x32_bf16 v[124:127], v[164:167], v[36:39], v[124:127]
    v_mfma_f32_16x16x32_bf16 v[120:123], v[196:199], v[36:39], v[120:123]
    v_mfma_f32_16x16x32_bf16 v[116:119], v[228:231], v[36:39], v[116:119]
    ds_read_b128 v[32:35], v12 offset:768
    s_waitcnt lgkmcnt(12)
    v_mfma_f32_16x16x32_bf16 v[124:127], v[168:171], v[40:43], v[124:127]
    v_mfma_f32_16x16x32_bf16 v[120:123], v[200:203], v[40:43], v[120:123]
    v_cvt_pk_bf16_f32 v78, v112, v113
    v_cvt_pk_bf16_f32 v79, v114, v115
    ds_write_b64 v5, v[78:79] offset:2048
    ds_add_u32 v13, v14 offset:48
    v_mfma_f32_16x16x32_bf16 v[116:119], v[232:235], v[40:43], v[116:119]
    ds_read_b128 v[36:39], v12 offset:832
    s_waitcnt lgkmcnt(14)
    v_mfma_f32_16x16x32_bf16 v[124:127], v[172:175], v[44:47], v[124:127]
    v_mfma_f32_16x16x32_bf16 v[120:123], v[204:207], v[44:47], v[120:123]
    v_mfma_f32_16x16x32_bf16 v[116:119], v[236:239], v[44:47], v[116:119]
    ds_read_b128 v[40:43], v12 offset:896
    s_waitcnt lgkmcnt(12)
    v_mfma_f32_16x16x32_bf16 v[124:127], v[176:179], v[48:51], v[124:127]
    v_mfma_f32_16x16x32_bf16 v[120:123], v[208:211], v[48:51], v[120:123]
    v_mfma_f32_16x16x32_bf16 v[116:119], v[240:243], v[48:51], v[116:119]
    ds_read_b128 v[44:47], v12 offset:960
    s_waitcnt lgkmcnt(12)
    v_mfma_f32_16x16x32_bf16 v[124:127], v[180:183], v[52:55], v[124:127]
    v_mfma_f32_16x16x32_bf16 v[120:123], v[212:215], v[52:55], v[120:123]
    v_mfma_f32_16x16x32_bf16 v[116:119], v[244:247], v[52:55], v[116:119]
    s_waitcnt lgkmcnt(11)
    v_mfma_f32_16x16x32_bf16 v[124:127], v[184:187], v[56:59], v[124:127]
    v_mfma_f32_16x16x32_bf16 v[120:123], v[216:219], v[56:59], v[120:123]
    v_mfma_f32_16x16x32_bf16 v[116:119], v[248:251], v[56:59], v[116:119]
    s_waitcnt lgkmcnt(10)
    v_mfma_f32_16x16x32_bf16 v[124:127], v[188:191], v[60:63], v[124:127]
    v_mfma_f32_16x16x32_bf16 v[120:123], v[220:223], v[60:63], v[120:123]
    v_mfma_f32_16x16x32_bf16 v[116:119], v[252:255], v[60:63], v[116:119]
    s_bitcmp1_b32 s97, 7
    s_cbranch_scc0 L_spin_16
L_ok_15:
    ds_read_b128 v[48:51], v12 offset:0
    ds_read_b128 v[52:55], v12 offset:64
    ds_read_b128 v[56:59], v12 offset:128
    s_waitcnt lgkmcnt(12)
    v_mfma_f32_16x16x32_bf16 v[124:127], v[192:195], v[80:83], v[124:127]
    v_mfma_f32_16x16x32_bf16 v[120:123], v[224:227], v[80:83], v[120:123]
    v_mfma_f32_16x16x32_bf16 v[120:123], v[74:77], v[80:83], v[120:123]
    ds_read_b128 v[60:63], v12 offset:192
    s_waitcnt lgkmcnt(12)
    v_mfma_f32_16x16x32_bf16 v[124:127], v[196:199], v[84:87], v[124:127]
    v_mfma_f32_16x16x32_bf16 v[120:123], v[228:231], v[84:87], v[120:123]
    ds_read_b128 v[80:83], v12 offset:256
    s_waitcnt lgkmcnt(12)
    v_mfma_f32_16x16x32_bf16 v[124:127], v[200:203], v[88:91], v[124:127]
    v_mfma_f32_16x16x32_bf16 v[120:123], v[232:235], v[88:91], v[120:123]
    ds_read_b128 v[84:87], v12 offset:320
    s_waitcnt lgkmcnt(12)
    v_mfma_f32_16x16x32_bf16 v[124:127], v[204:207], v[92:95], v[124:127]
    v_mfma_f32_16x16x32_bf16 v[120:123], v[236:239], v[92:95], v[120:123]
    v_cvt_pk_bf16_f32 v78, v116, v117
    v_cvt_pk_bf16_f32 v79, v118, v119
    ds_write_b64 v5, v[78:79] offset:2560
    ds_add_u32 v13, v14 offset:52
    ds_read_b128 v[88:91], v12 offset:384
    s_waitcnt lgkmcnt(14)
    v_mfma_f32_16x16x32_bf16 v[124:127], v[208:211], v[32:35], v[124:127]
    v_mfma_f32_16x16x32_bf16 v[120:123], v[240:243], v[32:35], v[120:123]
    ds_read_b128 v[92:95], v12 offset:448
    s_waitcnt lgkmcnt(12)
    v_mfma_f32_16x16x32_bf16 v[124:127], v[212:215], v[36:39], v[124:127]
    v_mfma_f32_16x16x32_bf16 v[120:123], v[244:247], v[36:39], v[120:123]
    s_waitcnt lgkmcnt(11)
    v_mfma_f32_16x16x32_bf16 v[124:127], v[216:219], v[40:43], v[124:127]
    v_mfma_f32_16x16x32_bf16 v[120:123], v[248:251], v[40:43], v[120:123]
    s_waitcnt lgkmcnt(10)
    v_mfma_f32_16x16x32_bf16 v[124:127], v[220:223], v[44:47], v[124:127]
    v_mfma_f32_16x16x32_bf16 v[120:123], v[252:255], v[44:47], v[120:123]
    s_waitcnt lgkmcnt(9)
    v_mfma_f32_16x16x32_bf16 v[124:127], v[224:227], v[48:51], v[124:127]
    v_mfma_f32_16x16x32_bf16 v[124:127], v[74:77], v[48:51], v[124:127]
    s_waitcnt lgkmcnt(8)
    v_mfma_f32_16x16x32_bf16 v[124:127], v[228:231], v[52:55], v[124:127]
    s_waitcnt lgkmcnt(7)
    v_mfma_f32_16x16x32_bf16 v[124:127], v[232:235], v[56:59], v[124:127]
    s_waitcnt lgkmcnt(6)
    v_mfma_f32_16x16x32_bf16 v[124:127], v[236:239], v[60:63], v[124:127]
    s_waitcnt lgkmcnt(5)
    v_mfma_f32_16x16x32_bf16 v[124:127], v[240:243], v[80:83], v[124:127]
    s_waitcnt lgkmcnt(4)
    v_mfma_f32_16x16x32_bf16 v[124:127], v[244:247], v[84:87], v[124:127]
    s_waitcnt lgkmcnt(1)
    v_mfma_f32_16x16x32_bf16 v[124:127], v[248:251], v[88:91], v[124:127]
    s_waitcnt lgkmcnt(0)
    v_mfma_f32_16x16x32_bf16 v[124:127], v[252:255], v[92:95], v[124:127]
    v_cvt_pk_bf16_f32 v78, v120, v121
    v_cvt_pk_bf16_f32 v79, v122, v123
    ds_write_b64 v5, v[78:79] offset:3072
    ds_add_u32 v13, v14 offset:56
    s_nop 7
    v_cvt_pk_bf16_f32 v78, v124, v125
    v_cvt_pk_bf16_f32 v79, v126, v127
    ds_write_b64 v5, v[78:79] offset:3584
    ds_add_u32 v13, v14 offset:60
    s_endpgm
L_A_hi:
    v_subrev_u32 v2, 1310720, v3
    v_subrev_u32 v6, 2048, v6
    buffer_load_dwordx4 v[16:19], v3, s[8:11], 0 offen offset:0
    buffer_load_dwordx4 v[20:23], v3, s[8:11], 0 offen offset:1280
    buffer_load_dwordx4 v[24:27], v3, s[8:11], 0 offen offset:2560
    buffer_load_dwordx4 v[28:31], v3, s[8:11], 0 offen offset:3840
    buffer_load_dwordx4 v[32:35], v3, s[12:15], 0 offen offset:0
    buffer_load_dwordx4 v[36:39], v3, s[12:15], 0 offen offset:1280
    buffer_load_dwordx4 v[40:43], v3, s[12:15], 0 offen offset:2560
    buffer_load_dwordx4 v[44:47], v3, s[12:15], 0 offen offset:3840
    s_setprio 1
    s_bitcmp1_b32 s97, 0
    s_cbranch_scc0 L_spin_18
L_ok_17:
    ds_read_b128 v[80:83], v12 offset:3584
    ds_read_b128 v[84:87], v12 offset:3648
    ds_read_b128 v[88:91], v12 offset:3712
    ds_read_b128 v[92:95], v12 offset:3776
    s_waitcnt lgkmcnt(3)
    v_mfma_f32_16x16x32_bf16 v[124:127], v[128:131], v[80:83], 0
    ds_read_b64 v[128:129], v8 offset:1536
    ds_read_b64 v[130:131], v8 offset:1544
    v_mfma_f32_16x16x32_bf16 v[120:123], v[160:163], v[80:83], 0
    v_mfma_f32_16x16x32_bf16 v[116:119], v[192:195], v[80:83], 0
    v_mfma_f32_16x16x32_bf16 v[112:115], v[224:227], v[80:83], 0
    ds_read_b128 v[80:83], v12 offset:3840
    s_waitcnt lgkmcnt(5)
    v_mfma_f32_16x16x32_bf16 v[124:127], v[132:135], v[84:87], v[124:127]
    ds_read_b64 v[132:133], v8 offset:1600
    ds_read_b64 v[134:135], v8 offset:1608
    v_mfma_f32_16x16x32_bf16 v[120:123], v[164:167], v[84:87], v[120:123]
    v_mfma_f32_16x16x32_bf16 v[116:119], v[196:199], v[84:87], v[116:119]
    v_mfma_f32_16x16x32_bf16 v[112:115], v[228:231], v[84:87], v[112:115]
    ds_read_b128 v[84:87], v12 offset:3904
    s_waitcnt lgkmcnt(7)
    v_mfma_f32_16x16x32_bf16 v[124:127], v[136:139], v[88:91], v[124:127]
    ds_read_b64 v[136:137], v8 offset:1664
    ds_read_b64 v[138:139], v8 offset:1672
    v_mfma_f32_16x16x32_bf16 v[120:123], v[168:171], v[88:91], v[120:123]
    v_mfma_f32_16x16x32_bf16 v[116:119], v[200:203], v[88:91], v[116:119]
    v_mfma_f32_16x16x32_bf16 v[112:115], v[232:235], v[88:91], v[112:115]
    ds_read_b128 v[88:91], v12 offset:3968
    s_waitcnt lgkmcnt(9)
    v_mfma_f32_16x16x32_bf16 v[124:127], v[140:143], v[92:95], v[124:127]
    ds_read_b64 v[140:141], v8 offset:1728
    ds_read_b64 v[142:143], v8 offset:1736
    v_mfma_f32_16x16x32_bf16 v[120:123], v[172:175], v[92:95], v[120:123]
    v_mfma_f32_16x16x32_bf16 v[116:119], v[204:207], v[92:95], v[116:119]
    v_mfma_f32_16x16x32_bf16 v[112:115], v[236:239], v[92:95], v[112:115]
    ds_read_b128 v[92:95], v12 offset:4032
    s_waitcnt lgkmcnt(9)
    v_mfma_f32_16x16x32_bf16 v[124:127], v[144:147], v[80:83], v[124:127]
    ds_read_b64 v[144:145], v8 offset:1792
    ds_read_b64 v[146:147], v8 offset:1800
    v_mfma_f32_16x16x32_bf16 v[120:123], v[176:179], v[80:83], v[120:123]
    v_mfma_f32_16x16x32_bf16 v[116:119], v[208:211], v[80:83], v[116:119]
    v_mfma_f32_16x16x32_bf16 v[112:115], v[240:243], v[80:83], v[112:115]
    s_bitcmp1_b32 s97, 1
    s_cbranch_scc0 L_spin_20
L_ok_19:
    ds_read_b128 v[80:83], v12 offset:3072
    s_waitcnt lgkmcnt(9)
    v_mfma_f32_16x16x32_bf16 v[124:127], v[148:151], v[84:87], v[124:127]
    ds_read_b64 v[148:149], v8 offset:1856
    ds_read_b64 v[150:151], v8 offset:1864
    v_mfma_f32_16x16x32_bf16 v[120:123], v[180:183], v[84:87], v[120:123]
    v_mfma_f32_16x16x32_bf16 v[116:119], v[212:215], v[84:87], v[116:119]
    v_mfma_f32_16x16x32_bf16 v[112:115], v[244:247], v[84:87], v[112:115]
    ds_read_b128 v[84:87], v12 offset:3136
    s_waitcnt lgkmcnt(9)
    v_mfma_f32_16x16x32_bf16 v[124:127], v[152:155], v[88:91], v[124:127]
    ds_read_b64 v[152:153], v8 offset:1920
    ds_read_b64 v[154:155], v8 offset:1928
    v_mfma_f32_16x16x32_bf16 v[120:123], v[184:187], v[88:91], v[120:123]
    v_mfma_f32_16x16x32_bf16 v[116:119], v[216:219], v[88:91], v[116:119]
    v_mfma_f32_16x16x32_bf16 v[112:115], v[248:251], v[88:91], v[112:115]
    ds_read_b128 v[88:91], v12 offset:3200
    s_waitcnt lgkmcnt(9)
    v_mfma_f32_16x16x32_bf16 v[124:127], v[156:159], v[92:95], v[124:127]
    ds_read_b64 v[156:157], v8 offset:1984
    ds_read_b64 v[158:159], v8 offset:1992
    v_mfma_f32_16x16x32_bf16 v[120:123], v[188:191], v[92:95], v[120:123]
    v_mfma_f32_16x16x32_bf16 v[116:119], v[220:223], v[92:95], v[116:119]
    v_mfma_f32_16x16x32_bf16 v[112:115], v[252:255], v[92:95], v[112:115]
    ds_read_b128 v[92:95], v12 offset:3264
    s_waitcnt lgkmcnt(9)
    v_mfma_f32_16x16x32_bf16 v[124:127], v[160:163], v[80:83], v[124:127]
    ds_read_b64 v[160:161], v8 offset:1024
    ds_read_b64 v[162:163], v8 offset:1032
    v_mfma_f32_16x16x32_bf16 v[120:123], v[192:195], v[80:83], v[120:123]
    v_mfma_f32_16x16x32_bf16 v[116:119], v[224:227], v[80:83], v[116:119]
    v_mfma_f32_16x16x32_bf16 v[112:115], v[128:131], v[80:83], v[112:115]
    ds_read_b128 v[80:83], v12 offset:3328
    s_waitcnt lgkmcnt(9)
    v_mfma_f32_16x16x32_bf16 v[124:127], v[164:167], v[84:87], v[124:127]
    ds_read_b64 v[164:165], v8 offset:1088
    ds_read_b64 v[166:167], v8 offset:1096
    v_mfma_f32_16x16x32_bf16 v[120:123], v[196:199], v[84:87], v[120:123]
    v_mfma_f32_16x16x32_bf16 v[116:119], v[228:231], v[84:87], v[116:119]
    v_mfma_f32_16x16x32_bf16 v[112:115], v[132:135], v[84:87], v[112:115]
    ds_read_b128 v[84:87], v12 offset:3392
    s_waitcnt lgkmcnt(9)
    v_mfma_f32_16x16x32_bf16 v[124:127], v[168:171], v[88:91], v[124:127]
    ds_read_b64 v[168:169], v8 offset:1152
    ds_read_b64 v[170:171], v8 offset:1160
    v_mfma_f32_16x16x32_bf16 v[120:123], v[200:203], v[88:91], v[120:123]
    v_mfma_f32_16x16x32_bf16 v[116:119], v[232:235], v[88:91], v[116:119]
    v_mfma_f32_16x16x32_bf16 v[112:115], v[136:139], v[88:91], v[112:115]
    ds_read_b128 v[88:91], v12 offset:3456
    s_waitcnt lgkmcnt(9)
    v_mfma_f32_16x16x32_bf16 v[124:127], v[172:175], v[92:95], v[124:127]
    ds_read_b64 v[172:173], v8 offset:1216
    ds_read_b64 v[174:175], v8 offset:1224
    v_mfma_f32_16x16x32_bf16 v[120:123], v[204:207], v[92:95], v[120:123]
    v_mfma_f32_16x16x32_bf16 v[116:119], v[236:239], v[92:95], v[116:119]
    v_mfma_f32_16x16x32_bf16 v[112:115], v[140:143], v[92:95], v[112:115]
    ds_read_b128 v[92:95], v12 offset:3520
    s_waitcnt lgkmcnt(9)
    v_mfma_f32_16x16x32_bf16 v[124:127], v[176:179], v[80:83], v[124:127]
    ds_read_b64 v[176:177], v8 offset:1280
    ds_read_b64 v[178:179], v8 offset:1288
    v_mfma_f32_16x16x32_bf16 v[120:123], v[208:211], v[80:83], v[120:123]
    v_mfma_f32_16x16x32_bf16 v[116:119], v[240:243], v[80:83], v[116:119]
    v_mfma_f32_16x16x32_bf16 v[112:115], v[144:147], v[80:83], v[112:115]
    s_bitcmp1_b32 s97, 2
    s_cbranch_scc0 L_spin_22
L_ok_21:
    ds_read_b128 v[80:83], v12 offset:2560
    s_waitcnt lgkmcnt(9)
    v_mfma_f32_16x16x32_bf16 v[124:127], v[180:183], v[84:87], v[124:127]
    ds_read_b64 v[180:181], v8 offset:1344
    ds_read_b64 v[182:183], v8 offset:1352
    v_mfma_f32_16x16x32_bf16 v[120:123], v[212:215], v[84:87], v[120:123]
    v_mfma_f32_16x16x32_bf16 v[116:119], v[244:247], v[84:87], v[116:119]
    v_mfma_f32_16x16x32_bf16 v[112:115], v[148:151], v[84:87], v[112:115]
    ds_read_b128 v[84:87], v12 offset:2624
    s_waitcnt lgkmcnt(9)
    v_mfma_f32_16x16x32_bf16 v[124:127], v[184:187], v[88:91], v[124:127]
    ds_read_b64 v[184:185], v8 offset:1408
    ds_read_b64 v[186:187], v8 offset:1416
    v_mfma_f32_16x16x32_bf16 v[120:123], v[216:219], v[88:91], v[120:123]
    v_mfma_f32_16x16x32_bf16 v[116:119], v[248:251], v[88:91], v[116:119]
    v_mfma_f32_16x16x32_bf16 v[112:115], v[152:155], v[88:91], v[112:115]
    ds_read_b128 v[88:91], v12 offset:2688
    s_waitcnt lgkmcnt(9)
    v_mfma_f32_16x16x32_bf16 v[124:127], v[188:191], v[92:95], v[124:127]
    ds_read_b64 v[188:189], v8 offset:1472
    ds_read_b64 v[190:191], v8 offset:1480
    v_mfma_f32_16x16x32_bf16 v[120:123], v[220:223], v[92:95], v[120:123]
    v_mfma_f32_16x16x32_bf16 v[116:119], v[252:255], v[92:95], v[116:119]
    v_mfma_f32_16x16x32_bf16 v[112:115], v[156:159], v[92:95], v[112:115]
    ds_read_b128 v[92:95], v12 offset:2752
    s_waitcnt lgkmcnt(9)
    v_mfma_f32_16x16x32_bf16 v[124:127], v[192:195], v[80:83], v[124:127]
    ds_read_b64 v[192:193], v8 offset:512
    ds_read_b64 v[194:195], v8 offset:520
    v_mfma_f32_16x16x32_bf16 v[120:123], v[224:227], v[80:83], v[120:123]
    v_mfma_f32_16x16x32_bf16 v[116:119], v[128:131], v[80:83], v[116:119]
    v_mfma_f32_16x16x32_bf16 v[112:115], v[160:163], v[80:83], v[112:115]
    ds_read_b128 v[80:83], v12 offset:2816
    s_waitcnt lgkmcnt(9)
    v_mfma_f32_16x16x32_bf16 v[124:127], v[196:199], v[84:87], v[124:127]
    ds_read_b64 v[196:197], v8 offset:576
    ds_read_b64 v[198:199], v8 offset:584
    v_mfma_f32_16x16x32_bf16 v[120:123], v[228:231], v[84:87], v[120:123]
    v_mfma_f32_16x16x32_bf16 v[116:119], v[132:135], v[84:87], v[116:119]
    v_mfma_f32_16x16x32_bf16 v[112:115], v[164:167], v[84:87], v[112:115]
    ds_read_b128 v[84:87], v12 offset:2880
    s_waitcnt lgkmcnt(9)
    v_mfma_f32_16x16x32_bf16 v[124:127], v[200:203], v[88:91], v[124:127]
    ds_read_b64 v[200:201], v8 offset:640
    ds_read_b64 v[202:203], v8 offset:648
    v_mfma_f32_16x16x32_bf16 v[120:123], v[232:235], v[88:91], v[120:123]
    v_mfma_f32_16x16x32_bf16 v[116:119], v[136:139], v[88:91], v[116:119]
    v_mfma_f32_16x16x32_bf16 v[112:115], v[168:171], v[88:91], v[112:115]
    ds_read_b128 v[88:91], v12 offset:2944
    s_waitcnt lgkmcnt(9)
    v_mfma_f32_16x16x32_bf16 v[124:127], v[204:207], v[92:95], v[124:127]
    ds_read_b64 v[204:205], v8 offset:704
    ds_read_b64 v[206:207], v8 offset:712
    v_mfma_f32_16x16x32_bf16 v[120:123], v[236:239], v[92:95], v[120:123]
    v_mfma_f32_16x16x32_bf16 v[116:119], v[140:143], v[92:95], v[116:119]
    v_mfma_f32_16x16x32_bf16 v[112:115], v[172:175], v[92:95], v[112:115]
    ds_read_b128 v[92:95], v12 offset:3008
    s_waitcnt lgkmcnt(9)
    v_mfma_f32_16x16x32_bf16 v[124:127], v[208:211], v[80:83], v[124:127]
    ds_read_b64 v[208:209], v8 offset:768
    ds_read_b64 v[210:211], v8 offset:776
    v_mfma_f32_16x16x32_bf16 v[120:123], v[240:243], v[80:83], v[120:123]
    v_mfma_f32_16x16x32_bf16 v[116:119], v[144:147], v[80:83], v[116:119]
    v_mfma_f32_16x16x32_bf16 v[112:115], v[176:179], v[80:83], v[112:115]
    s_bitcmp1_b32 s97, 3
    s_cbranch_scc0 L_spin_24
L_ok_23:
    ds_read_b128 v[80:83], v12 offset:2048
    s_waitcnt lgkmcnt(9)
    v_mfma_f32_16x16x32_bf16 v[124:127], v[212:215], v[84:87], v[124:127]
    ds_read_b64 v[212:213], v8 offset:832
    ds_read_b64 v[214:215], v8 offset:840
    v_mfma_f32_16x16x32_bf16 v[120:123], v[244:247], v[84:87], v[120:123]
    v_mfma_f32_16x16x32_bf16 v[116:119], v[148:151], v[84:87], v[116:119]
    v_mfma_f32_16x16x32_bf16 v[112:115], v[180:183], v[84:87], v[112:115]
    ds_read_b128 v[84:87], v12 offset:2112
    s_waitcnt lgkmcnt(9)
    v_mfma_f32_16x16x32_bf16 v[124:127], v[216:219], v[88:91], v[124:127]
    ds_read_b64 v[216:217], v8 offset:896
    ds_read_b64 v[218:219], v8 offset:904
    v_mfma_f32_16x16x32_bf16 v[120:123], v[248:251], v[88:91], v[120:123]
    v_mfma_f32_16x16x32_bf16 v[116:119], v[152:155], v[88:91], v[116:119]
    v_mfma_f32_16x16x32_bf16 v[112:115], v[184:187], v[88:91], v[112:115]
    ds_read_b128 v[88:91], v12 offset:2176
    s_waitcnt lgkmcnt(9)
    v_mfma_f32_16x16x32_bf16 v[124:127], v[220:223], v[92:95], v[124:127]
    ds_read_b64 v[220:221], v8 offset:960
    ds_read_b64 v[222:223], v8 offset:968
    v_mfma_f32_16x16x32_bf16 v[120:123], v[252:255], v[92:95], v[120:123]
    v_mfma_f32_16x16x32_bf16 v[116:119], v[156:159], v[92:95], v[116:119]
    v_mfma_f32_16x16x32_bf16 v[112:115], v[188:191], v[92:95], v[112:115]
    ds_read_b128 v[92:95], v12 offset:2240
    s_waitcnt lgkmcnt(9)
    v_mfma_f32_16x16x32_bf16 v[124:127], v[224:227], v[80:83], v[124:127]
    ds_read_b64 v[224:225], v8 offset:0
    ds_read_b64 v[226:227], v8 offset:8
    v_mfma_f32_16x16x32_bf16 v[120:123], v[128:131], v[80:83], v[120:123]
    v_mfma_f32_16x16x32_bf16 v[116:119], v[160:163], v[80:83], v[116:119]
    v_mfma_f32_16x16x32_bf16 v[112:115], v[192:195], v[80:83], v[112:115]
    ds_read_b128 v[80:83], v12 offset:2304
    s_waitcnt lgkmcnt(9)
    v_mfma_f32_16x16x32_bf16 v[124:127], v[228:231], v[84:87], v[124:127]
    ds_read_b64 v[228:229], v8 offset:64
    ds_read_b64 v[230:231], v8 offset:72
    v_mfma_f32_16x16x32_bf16 v[120:123], v[132:135], v[84:87], v[120:123]
    v_mfma_f32_16x16x32_bf16 v[116:119], v[164:167], v[84:87], v[116:119]
    v_mfma_f32_16x16x32_bf16 v[112:115], v[196:199], v[84:87], v[112:115]
    ds_read_b128 v[84:87], v12 offset:2368
    s_waitcnt lgkmcnt(9)
    v_mfma_f32_16x16x32_bf16 v[124:127], v[232:235], v[88:91], v[124:127]
    ds_read_b64 v[232:233], v8 offset:128
    ds_read_b64 v[234:235], v8 offset:136
    v_mfma_f32_16x16x32_bf16 v[120:123], v[136:139], v[88:91], v[120:123]
    v_mfma_f32_16x16x32_bf16 v[116:119], v[168:171], v[88:91], v[116:119]
    v_mfma_f32_16x16x32_bf16 v[112:115], v[200:203], v[88:91], v[112:115]
    ds_read_b128 v[88:91], v12 offset:2432
    s_waitcnt lgkmcnt(9)
    v_mfma_f32_16x16x32_bf16 v[124:127], v[236:239], v[92:95], v[124:127]
    ds_read_b64 v[236:237], v8 offset:192
    ds_read_b64 v[238:239], v8 offset:200
    v_mfma_f32_16x16x32_bf16 v[120:123], v[140:143], v[92:95], v[120:123]
    v_mfma_f32_16x16x32_bf16 v[116:119], v[172:175], v[92:95], v[116:119]
    v_mfma_f32_16x16x32_bf16 v[112:115], v[204:207], v[92:95], v[112:115]
    ds_read_b128 v[92:95], v12 offset:2496
    s_waitcnt lgkmcnt(9)
    v_mfma_f32_16x16x32_bf16 v[124:127], v[240:243], v[80:83], v[124:127]
    ds_read_b64 v[240:241], v8 offset:256
    ds_read_b64 v[242:243], v8 offset:264
    v_mfma_f32_16x16x32_bf16 v[120:123], v[144:147], v[80:83], v[120:123]
    v_mfma_f32_16x16x32_bf16 v[116:119], v[176:179], v[80:83], v[116:119]
    v_mfma_f32_16x16x32_bf16 v[112:115], v[208:211], v[80:83], v[112:115]
    ds_read_b128 v[80:83], v12 offset:3584
    s_waitcnt lgkmcnt(9)
    v_mfma_f32_16x16x32_bf16 v[124:127], v[244:247], v[84:87], v[124:127]
    ds_read_b64 v[244:245], v8 offset:320
    ds_read_b64 v[246:247], v8 offset:328
    v_mfma_f32_16x16x32_bf16 v[120:123], v[148:151], v[84:87], v[120:123]
    v_mfma_f32_16x16x32_bf16 v[116:119], v[180:183], v[84:87], v[116:119]
    v_mfma_f32_16x16x32_bf16 v[112:115], v[212:215], v[84:87], v[112:115]
    ds_read_b128 v[84:87], v12 offset:3648
    s_waitcnt lgkmcnt(9)
    v_mfma_f32_16x16x32_bf16 v[124:127], v[248:251], v[88:91], v[124:127]
    ds_read_b64 v[248:249], v8 offset:384
    ds_read_b64 v[250:251], v8 offset:392
    v_mfma_f32_16x16x32_bf16 v[120:123], v[152:155], v[88:91], v[120:123]
    v_mfma_f32_16x16x32_bf16 v[116:119], v[184:187], v[88:91], v[116:119]
    v_mfma_f32_16x16x32_bf16 v[112:115], v[216:219], v[88:91], v[112:115]
    ds_read_b128 v[88:91], v12 offset:3712
    s_waitcnt lgkmcnt(9)
    v_mfma_f32_16x16x32_bf16 v[124:127], v[252:255], v[92:95], v[124:127]
    ds_read_b64 v[252:253], v8 offset:448
    ds_read_b64 v[254:255], v8 offset:456
    v_mfma_f32_16x16x32_bf16 v[120:123], v[156:159], v[92:95], v[120:123]
    v_mfma_f32_16x16x32_bf16 v[116:119], v[188:191], v[92:95], v[116:119]
    v_mfma_f32_16x16x32_bf16 v[112:115], v[220:223], v[92:95], v[112:115]
    ds_read_b128 v[92:95], v12 offset:3776
    s_waitcnt lgkmcnt(9)
    v_mfma_f32_16x16x32_bf16 v[108:111], v[128:131], v[80:83], 0
    v_mfma_f32_16x16x32_bf16 v[104:107], v[160:163], v[80:83], 0
    v_mfma_f32_16x16x32_bf16 v[100:103], v[192:195], v[80:83], 0
    v_mfma_f32_16x16x32_bf16 v[96:99], v[224:227], v[80:83], 0
    v_mfma_f32_16x16x32_bf16 v[96:99], v[74:77], v[80:83], v[96:99]
    ds_read_b128 v[80:83], v12 offset:3840
    s_waitcnt lgkmcnt(7)
    v_mfma_f32_16x16x32_bf16 v[108:111], v[132:135], v[84:87], v[108:111]
    v_mfma_f32_16x16x32_bf16 v[104:107], v[164:167], v[84:87], v[104:107]
    v_mfma_f32_16x16x32_bf16 v[100:103], v[196:199], v[84:87], v[100:103]
    v_mfma_f32_16x16x32_bf16 v[96:99], v[228:231], v[84:87], v[96:99]
    ds_read_b128 v[84:87], v12 offset:3904
    s_waitcnt lgkmcnt(5)
    v_mfma_f32_16x16x32_bf16 v[108:111], v[136:139], v[88:91], v[108:111]
    v_mfma_f32_16x16x32_bf16 v[104:107], v[168:171], v[88:91], v[104:107]
    v_mfma_f32_16x16x32_bf16 v[100:103], v[200:203], v[88:91], v[100:103]
    v_mfma_f32_16x16x32_bf16 v[96:99], v[232:235], v[88:91], v[96:99]
    ds_read_b128 v[88:91], v12 offset:3968
    s_waitcnt lgkmcnt(3)
    v_mfma_f32_16x16x32_bf16 v[108:111], v[140:143], v[92:95], v[108:111]
    v_mfma_f32_16x16x32_bf16 v[104:107], v[172:175], v[92:95], v[104:107]
    v_mfma_f32_16x16x32_bf16 v[100:103], v[204:207], v[92:95], v[100:103]
    v_mfma_f32_16x16x32_bf16 v[96:99], v[236:239], v[92:95], v[96:99]
    ds_read_b128 v[92:95], v12 offset:4032
    s_waitcnt lgkmcnt(3)
    v_mfma_f32_16x16x32_bf16 v[108:111], v[144:147], v[80:83], v[108:111]
    v_mfma_f32_16x16x32_bf16 v[104:107], v[176:179], v[80:83], v[104:107]
    v_mfma_f32_16x16x32_bf16 v[100:103], v[208:211], v[80:83], v[100:103]
    v_mfma_f32_16x16x32_bf16 v[96:99], v[240:243], v[80:83], v[96:99]
    ds_read_b128 v[80:83], v12 offset:3072
    s_waitcnt lgkmcnt(3)
    v_mfma_f32_16x16x32_bf16 v[108:111], v[148:151], v[84:87], v[108:111]
    v_mfma_f32_16x16x32_bf16 v[104:107], v[180:183], v[84:87], v[104:107]
    v_mfma_f32_16x16x32_bf16 v[100:103], v[212:215], v[84:87], v[100:103]
    v_mfma_f32_16x16x32_bf16 v[96:99], v[244:247], v[84:87], v[96:99]
    ds_read_b128 v[84:87], v12 offset:3136
    s_waitcnt lgkmcnt(3)
    v_mfma_f32_16x16x32_bf16 v[108:111], v[152:155], v[88:91], v[108:111]
    v_mfma_f32_16x16x32_bf16 v[104:107], v[184:187], v[88:91], v[104:107]
    v_mfma_f32_16x16x32_bf16 v[100:103], v[216:219], v[88:91], v[100:103]
    v_mfma_f32_16x16x32_bf16 v[96:99], v[248:251], v[88:91], v[96:99]
    ds_read_b128 v[88:91], v12 offset:3200
    s_waitcnt lgkmcnt(3)
    v_mfma_f32_16x16x32_bf16 v[108:111], v[156:159], v[92:95], v[108:111]
    v_mfma_f32_16x16x32_bf16 v[104:107], v[188:191], v[92:95], v[104:107]
    v_mfma_f32_16x16x32_bf16 v[100:103], v[220:223], v[92:95], v[100:103]
    v_mfma_f32_16x16x32_bf16 v[96:99], v[252:255], v[92:95], v[96:99]
    ds_read_b128 v[92:95], v12 offset:3264
    s_waitcnt lgkmcnt(3)
    v_mfma_f32_16x16x32_bf16 v[108:111], v[160:163], v[80:83], v[108:111]
    v_mfma_f32_16x16x32_bf16 v[104:107], v[192:195], v[80:83], v[104:107]
    v_mfma_f32_16x16x32_bf16 v[100:103], v[224:227], v[80:83], v[100:103]
    v_mfma_f32_16x16x32_bf16 v[100:103], v[74:77], v[80:83], v[100:103]
    ds_read_b128 v[80:83], v12 offset:3328
    s_waitcnt lgkmcnt(3)
    v_mfma_f32_16x16x32_bf16 v[108:111], v[164:167], v[84:87], v[108:111]
    v_mfma_f32_16x16x32_bf16 v[104:107], v[196:199], v[84:87], v[104:107]
    v_mfma_f32_16x16x32_bf16 v[100:103], v[228:231], v[84:87], v[100:103]
    ds_read_b128 v[84:87], v12 offset:3392
    s_waitcnt lgkmcnt(3)
    v_mfma_f32_16x16x32_bf16 v[108:111], v[168:171], v[88:91], v[108:111]
    v_mfma_f32_16x16x32_bf16 v[104:107], v[200:203], v[88:91], v[104:107]
    v_cvt_pk_bf16_f32 v78, v96, v97
    v_cvt_pk_bf16_f32 v79, v98, v99
    ds_write_b64 v5, v[78:79] offset:0
    ds_add_u32 v13, v14 offset:32
    v_mfma_f32_16x16x32_bf16 v[100:103], v[232:235], v[88:91], v[100:103]
    ds_read_b128 v[88:91], v12 offset:3456
    s_waitcnt lgkmcnt(5)
    v_mfma_f32_16x16x32_bf16 v[108:111], v[172:175], v[92:95], v[108:111]
    v_mfma_f32_16x16x32_bf16 v[104:107], v[204:207], v[92:95], v[104:107]
    v_mfma_f32_16x16x32_bf16 v[100:103], v[236:239], v[92:95], v[100:103]
    ds_read_b128 v[92:95], v12 offset:3520
    s_waitcnt lgkmcnt(5)
    v_mfma_f32_16x16x32_bf16 v[108:111], v[176:179], v[80:83], v[108:111]
    v_mfma_f32_16x16x32_bf16 v[104:107], v[208:211], v[80:83], v[104:107]
    v_mfma_f32_16x16x32_bf16 v[100:103], v[240:243], v[80:83], v[100:103]
    ds_read_b128 v[80:83], v12 offset:2560
    s_waitcnt lgkmcnt(5)
    v_mfma_f32_16x16x32_bf16 v[108:111], v[180:183], v[84:87], v[108:111]
    v_mfma_f32_16x16x32_bf16 v[104:107], v[212:215], v[84:87], v[104:107]
    v_mfma_f32_16x16x32_bf16 v[100:103], v[244:247], v[84:87], v[100:103]
    ds_read_b128 v[84:87], v12 offset:2624
    s_waitcnt lgkmcnt(3)
    v_mfma_f32_16x16x32_bf16 v[108:111], v[184:187], v[88:91], v[108:111]
    v_mfma_f32_16x16x32_bf16 v[104:107], v[216:219], v[88:91], v[104:107]
    v_mfma_f32_16x16x32_bf16 v[100:103], v[248:251], v[88:91], v[100:103]
    ds_read_b128 v[88:91], v12 offset:2688
    s_waitcnt lgkmcnt(3)
    v_mfma_f32_16x16x32_bf16 v[108:111], v[188:191], v[92:95], v[108:111]
    v_mfma_f32_16x16x32_bf16 v[104:107], v[220:223], v[92:95], v[104:107]
    v_mfma_f32_16x16x32_bf16 v[100:103], v[252:255], v[92:95], v[100:103]
    ds_read_b128 v[92:95], v12 offset:2752
    s_waitcnt lgkmcnt(3)
    v_mfma_f32_16x16x32_bf16 v[108:111], v[192:195], v[80:83], v[108:111]
    v_mfma_f32_16x16x32_bf16 v[104:107], v[224:227], v[80:83], v[104:107]
    v_mfma_f32_16x16x32_bf16 v[104:107], v[74:77], v[80:83], v[104:107]
    ds_read_b128 v[80:83], v12 offset:2816
    s_waitcnt lgkmcnt(3)
    v_mfma_f32_16x16x32_bf16 v[108:111], v[196:199], v[84:87], v[108:111]
    v_mfma_f32_16x16x32_bf16 v[104:107], v[228:231], v[84:87], v[104:107]
    ds_read_b128 v[84:87], v12 offset:2880
    s_waitcnt lgkmcnt(3)
    v_mfma_f32_16x16x32_bf16 v[108:111], v[200:203], v[88:91], v[108:111]
    v_mfma_f32_16x16x32_bf16 v[104:107], v[232:235], v[88:91], v[104:107]
    ds_read_b128 v[88:91], v12 offset:2944
    s_waitcnt lgkmcnt(3)
    v_mfma_f32_16x16x32_bf16 v[108:111], v[204:207], v[92:95], v[108:111]
    v_mfma_f32_16x16x32_bf16 v[104:107], v[236:239], v[92:95], v[104:107]
    v_cvt_pk_bf16_f32 v78, v100, v101
    v_cvt_pk_bf16_f32 v79, v102, v103
    ds_write_b64 v5, v[78:79] offset:512
    ds_add_u32 v13, v14 offset:36
    ds_read_b128 v[92:95], v12 offset:3008
    s_waitcnt lgkmcnt(5)
    v_mfma_f32_16x16x32_bf16 v[108:111], v[208:211], v[80:83], v[108:111]
    v_mfma_f32_16x16x32_bf16 v[104:107], v[240:243], v[80:83], v[104:107]
    s_waitcnt lgkmcnt(4)
    v_mfma_f32_16x16x32_bf16 v[108:111], v[212:215], v[84:87], v[108:111]
    v_mfma_f32_16x16x32_bf16 v[104:107], v[244:247], v[84:87], v[104:107]
    s_waitcnt lgkmcnt(3)
    v_mfma_f32_16x16x32_bf16 v[108:111], v[216:219], v[88:91], v[108:111]
    v_mfma_f32_16x16x32_bf16 v[104:107], v[248:251], v[88:91], v[104:107]
    s_waitcnt lgkmcnt(0)
    v_mfma_f32_16x16x32_bf16 v[108:111], v[220:223], v[92:95], v[108:111]
    v_mfma_f32_16x16x32_bf16 v[104:107], v[252:255], v[92:95], v[104:107]
    s_nop 7
    v_cvt_pk_bf16_f32 v78, v104, v105
    v_cvt_pk_bf16_f32 v79, v106, v107
    ds_write_b64 v5, v[78:79] offset:1024
    ds_add_u32 v13, v14 offset:40
    s_waitcnt vmcnt(0)
    v_mov_b32 v48, s84
    v_mov_b32 v49, s88
    v_mov_b32 v50, s92
    v_lshlrev_b32 v58, 16, v16
    v_and_b32 v59, 0xffff0000, v16
    v_lshlrev_b32 v60, 16, v20
    v_and_b32 v61, 0xffff0000, v20
    v_lshlrev_b32 v62, 16, v24
    v_and_b32 v63, 0xffff0000, v24
    v_lshlrev_b32 v64, 16, v28
    v_and_b32 v65, 0xffff0000, v28
    v_mov_b32_dpp v48, v20 wave_shr:1 row_mask:0xf bank_mask:0xf
    v_mov_b32_dpp v49, v24 wave_shr:1 row_mask:0xf bank_mask:0xf
    v_mov_b32_dpp v50, v28 wave_shr:1 row_mask:0xf bank_mask:0xf
    v_pk_mul_f32 v[66:67], s[32:33], v[58:59]
    v_pk_mul_f32 v[68:69], s[32:33], v[60:61]
    v_pk_mul_f32 v[70:71], s[32:33], v[62:63]
    v_pk_mul_f32 v[72:73], s[32:33], v[64:65]
    v_lshlrev_b32 v52, 16, v48
    v_and_b32 v53, 0xffff0000, v48
    v_lshlrev_b32 v54, 16, v49
    v_and_b32 v55, 0xffff0000, v49
    v_lshlrev_b32 v56, 16, v50
    v_and_b32 v57, 0xffff0000, v50
    v_pk_fma_f32 v[66:67], s[34:35], v[56:57], v[66:67]
    v_pk_fma_f32 v[68:69], s[34:35], v[58:59], v[68:69]
    v_pk_fma_f32 v[70:71], s[34:35], v[60:61], v[70:71]
    v_pk_fma_f32 v[72:73], s[34:35], v[62:63], v[72:73]
    v_pk_fma_f32 v[66:67], s[36:37], v[54:55], v[66:67]
    v_pk_fma_f32 v[68:69], s[36:37], v[56:57], v[68:69]
    v_pk_fma_f32 v[70:71], s[36:37], v[58:59], v[70:71]
    v_pk_fma_f32 v[72:73], s[36:37], v[60:61], v[72:73]
    v_pk_fma_f32 v[66:67], s[38:39], v[52:53], v[66:67]
    v_pk_fma_f32 v[68:69], s[38:39], v[54:55], v[68:69]
    v_pk_fma_f32 v[70:71], s[38:39], v[56:57], v[70:71]
    v_pk_fma_f32 v[72:73], s[38:39], v[58:59], v[72:73]
    v_lshlrev_b32 v52, 16, v32
    v_and_b32 v53, 0xffff0000, v32
    v_lshlrev_b32 v54, 16, v36
    v_and_b32 v55, 0xffff0000, v36
    v_lshlrev_b32 v56, 16, v40
    v_and_b32 v57, 0xffff0000, v40
    v_lshlrev_b32 v58, 16, v44
    v_and_b32 v59, 0xffff0000, v44
    v_pk_mul_f32 v[66:67], v[66:67], v[52:53]
    v_pk_mul_f32 v[68:69], v[68:69], v[54:55]
    v_pk_mul_f32 v[70:71], v[70:71], v[56:57]
    v_pk_mul_f32 v[72:73], v[72:73], v[58:59]
    v_cvt_pk_bf16_f32 v60, v72, v70
    v_cvt_pk_bf16_f32 v61, v68, v66
    ds_write_b64 v4, v[60:61] offset:0
    v_cvt_pk_bf16_f32 v62, v73, v71
    v_cvt_pk_bf16_f32 v63, v69, v67
    ds_write_b64 v4, v[62:63] offset:4608
    v_mov_b32 v48, s85
    v_mov_b32 v49, s89
    v_mov_b32 v50, s93
    v_lshlrev_b32 v58, 16, v17
    v_and_b32 v59, 0xffff0000, v17
    v_lshlrev_b32 v60, 16, v21
    v_and_b32 v61, 0xffff0000, v21
    v_lshlrev_b32 v62, 16, v25
    v_and_b32 v63, 0xffff0000, v25
    v_lshlrev_b32 v64, 16, v29
    v_and_b32 v65, 0xffff0000, v29
    v_mov_b32_dpp v48, v21 wave_shr:1 row_mask:0xf bank_mask:0xf
    v_mov_b32_dpp v49, v25 wave_shr:1 row_mask:0xf bank_mask:0xf
    v_mov_b32_dpp v50, v29 wave_shr:1 row_mask:0xf bank_mask:0xf
    v_pk_mul_f32 v[66:67], s[40:41], v[58:59]
    v_pk_mul_f32 v[68:69], s[40:41], v[60:61]
    v_pk_mul_f32 v[70:71], s[40:41], v[62:63]
    v_pk_mul_f32 v[72:73], s[40:41], v[64:65]
    v_lshlrev_b32 v52, 16, v48
    v_and_b32 v53, 0xffff0000, v48
    v_lshlrev_b32 v54, 16, v49
    v_and_b32 v55, 0xffff0000, v49
    v_lshlrev_b32 v56, 16, v50
    v_and_b32 v57, 0xffff0000, v50
    v_pk_fma_f32 v[66:67], s[42:43], v[56:57], v[66:67]
    v_pk_fma_f32 v[68:69], s[42:43], v[58:59], v[68:69]
    v_pk_fma_f32 v[70:71], s[42:43], v[60:61], v[70:71]
    v_pk_fma_f32 v[72:73], s[42:43], v[62:63], v[72:73]
    v_pk_fma_f32 v[66:67], s[44:45], v[54:55], v[66:67]
    v_pk_fma_f32 v[68:69], s[44:45], v[56:57], v[68:69]
    v_pk_fma_f32 v[70:71], s[44:45], v[58:59], v[70:71]
    v_pk_fma_f32 v[72:73], s[44:45], v[60:61], v[72:73]
    v_pk_fma_f32 v[66:67], s[46:47], v[52:53], v[66:67]
    v_pk_fma_f32 v[68:69], s[46:47], v[54:55], v[68:69]
    v_pk_fma_f32 v[70:71], s[46:47], v[56:57], v[70:71]
    v_pk_fma_f32 v[72:73], s[46:47], v[58:59], v[72:73]
    v_lshlrev_b32 v52, 16, v33
    v_and_b32 v53, 0xffff0000, v33
    v_lshlrev_b32 v54, 16, v37
    v_and_b32 v55, 0xffff0000, v37
    v_lshlrev_b32 v56, 16, v41
    v_and_b32 v57, 0xffff0000, v41
    v_lshlrev_b32 v58, 16, v45
    v_and_b32 v59, 0xffff0000, v45
    v_pk_mul_f32 v[66:67], v[66:67], v[52:53]
    v_pk_mul_f32 v[68:69], v[68:69], v[54:55]
    v_pk_mul_f32 v[70:71], v[70:71], v[56:57]
    v_pk_mul_f32 v[72:73], v[72:73], v[58:59]
    v_cvt_pk_bf16_f32 v60, v72, v70
    v_cvt_pk_bf16_f32 v61, v68, v66
    ds_write_b64 v4, v[60:61] offset:9216
    v_cvt_pk_bf16_f32 v62, v73, v71
    v_cvt_pk_bf16_f32 v63, v69, v67
    ds_write_b64 v4, v[62:63] offset:13824
    v_mov_b32 v48, s86
    v_mov_b32 v49, s90
    v_mov_b32 v50, s94
    v_lshlrev_b32 v58, 16, v18
    v_and_b32 v59, 0xffff0000, v18
    v_lshlrev_b32 v60, 16, v22
    v_and_b32 v61, 0xffff0000, v22
    v_lshlrev_b32 v62, 16, v26
    v_and_b32 v63, 0xffff0000, v26
    v_lshlrev_b32 v64, 16, v30
    v_and_b32 v65, 0xffff0000, v30
    v_mov_b32_dpp v48, v22 wave_shr:1 row_mask:0xf bank_mask:0xf
    v_mov_b32_dpp v49, v26 wave_shr:1 row_mask:0xf bank_mask:0xf
    v_mov_b32_dpp v50, v30 wave_shr:1 row_mask:0xf bank_mask:0xf
    v_pk_mul_f32 v[66:67], s[48:49], v[58:59]
    v_pk_mul_f32 v[68:69], s[48:49], v[60:61]
    v_pk_mul_f32 v[70:71], s[48:49], v[62:63]
    v_pk_mul_f32 v[72:73], s[48:49], v[64:65]
    v_lshlrev_b32 v52, 16, v48
    v_and_b32 v53, 0xffff0000, v48
    v_lshlrev_b32 v54, 16, v49
    v_and_b32 v55, 0xffff0000, v49
    v_lshlrev_b32 v56, 16, v50
    v_and_b32 v57, 0xffff0000, v50
    v_pk_fma_f32 v[66:67], s[50:51], v[56:57], v[66:67]
    v_pk_fma_f32 v[68:69], s[50:51], v[58:59], v[68:69]
    v_pk_fma_f32 v[70:71], s[50:51], v[60:61], v[70:71]
    v_pk_fma_f32 v[72:73], s[50:51], v[62:63], v[72:73]
    v_pk_fma_f32 v[66:67], s[52:53], v[54:55], v[66:67]
    v_pk_fma_f32 v[68:69], s[52:53], v[56:57], v[68:69]
    v_pk_fma_f32 v[70:71], s[52:53], v[58:59], v[70:71]
    v_pk_fma_f32 v[72:73], s[52:53], v[60:61], v[72:73]
    v_pk_fma_f32 v[66:67], s[54:55], v[52:53], v[66:67]
    v_pk_fma_f32 v[68:69], s[54:55], v[54:55], v[68:69]
    v_pk_fma_f32 v[70:71], s[54:55], v[56:57], v[70:71]
    v_pk_fma_f32 v[72:73], s[54:55], v[58:59], v[72:73]
    v_lshlrev_b32 v52, 16, v34
    v_and_b32 v53, 0xffff0000, v34
    v_lshlrev_b32 v54, 16, v38
    v_and_b32 v55, 0xffff0000, v38
    v_lshlrev_b32 v56, 16, v42
    v_and_b32 v57, 0xffff0000, v42
    v_lshlrev_b32 v58, 16, v46
    v_and_b32 v59, 0xffff0000, v46
    v_pk_mul_f32 v[66:67], v[66:67], v[52:53]
    v_pk_mul_f32 v[68:69], v[68:69], v[54:55]
    v_pk_mul_f32 v[70:71], v[70:71], v[56:57]
    v_pk_mul_f32 v[72:73], v[72:73], v[58:59]
    v_cvt_pk_bf16_f32 v60, v72, v70
    v_cvt_pk_bf16_f32 v61, v68, v66
    ds_write_b64 v4, v[60:61] offset:18432
    v_cvt_pk_bf16_f32 v62, v73, v71
    v_cvt_pk_bf16_f32 v63, v69, v67
    ds_write_b64 v4, v[62:63] offset:23040
    v_mov_b32 v48, s87
    v_mov_b32 v49, s91
    v_mov_b32 v50, s95
    v_lshlrev_b32 v58, 16, v19
    v_and_b32 v59, 0xffff0000, v19
    v_lshlrev_b32 v60, 16, v23
    v_and_b32 v61, 0xffff0000, v23
    v_lshlrev_b32 v62, 16, v27
    v_and_b32 v63, 0xffff0000, v27
    v_lshlrev_b32 v64, 16, v31
    v_and_b32 v65, 0xffff0000, v31
    v_mov_b32_dpp v48, v23 wave_shr:1 row_mask:0xf bank_mask:0xf
    v_mov_b32_dpp v49, v27 wave_shr:1 row_mask:0xf bank_mask:0xf
    v_mov_b32_dpp v50, v31 wave_shr:1 row_mask:0xf bank_mask:0xf
    v_pk_mul_f32 v[66:67], s[56:57], v[58:59]
    v_pk_mul_f32 v[68:69], s[56:57], v[60:61]
    v_pk_mul_f32 v[70:71], s[56:57], v[62:63]
    v_pk_mul_f32 v[72:73], s[56:57], v[64:65]
    v_lshlrev_b32 v52, 16, v48
    v_and_b32 v53, 0xffff0000, v48
    v_lshlrev_b32 v54, 16, v49
    v_and_b32 v55, 0xffff0000, v49
    v_lshlrev_b32 v56, 16, v50
    v_and_b32 v57, 0xffff0000, v50
    v_pk_fma_f32 v[66:67], s[58:59], v[56:57], v[66:67]
    v_pk_fma_f32 v[68:69], s[58:59], v[58:59], v[68:69]
    v_pk_fma_f32 v[70:71], s[58:59], v[60:61], v[70:71]
    v_pk_fma_f32 v[72:73], s[58:59], v[62:63], v[72:73]
    v_pk_fma_f32 v[66:67], s[60:61], v[54:55], v[66:67]
    v_pk_fma_f32 v[68:69], s[60:61], v[56:57], v[68:69]
    v_pk_fma_f32 v[70:71], s[60:61], v[58:59], v[70:71]
    v_pk_fma_f32 v[72:73], s[60:61], v[60:61], v[72:73]
    v_pk_fma_f32 v[66:67], s[62:63], v[52:53], v[66:67]
    v_pk_fma_f32 v[68:69], s[62:63], v[54:55], v[68:69]
    v_pk_fma_f32 v[70:71], s[62:63], v[56:57], v[70:71]
    v_pk_fma_f32 v[72:73], s[62:63], v[58:59], v[72:73]
    v_lshlrev_b32 v52, 16, v35
    v_and_b32 v53, 0xffff0000, v35
    v_lshlrev_b32 v54, 16, v39
    v_and_b32 v55, 0xffff0000, v39
    v_lshlrev_b32 v56, 16, v43
    v_and_b32 v57, 0xffff0000, v43
    v_lshlrev_b32 v58, 16, v47
    v_and_b32 v59, 0xffff0000, v47
    v_pk_mul_f32 v[66:67], v[66:67], v[52:53]
    v_pk_mul_f32 v[68:69], v[68:69], v[54:55]
    v_pk_mul_f32 v[70:71], v[70:71], v[56:57]
    v_pk_mul_f32 v[72:73], v[72:73], v[58:59]
    v_cvt_pk_bf16_f32 v60, v72, v70
    v_cvt_pk_bf16_f32 v61, v68, v66
    ds_write_b64 v4, v[60:61] offset:27648
    v_cvt_pk_bf16_f32 v62, v73, v71
    v_cvt_pk_bf16_f32 v63, v69, v67
    ds_write_b64 v4, v[62:63] offset:32256
    ds_write_b32 v7, v14 offset:0
    ds_read_b128 v[80:83], v12 offset:2048
    ds_read_b128 v[84:87], v12 offset:2112
    ds_read_b128 v[88:91], v12 offset:2176
    ds_read_b128 v[92:95], v12 offset:2240
    ds_read_b128 v[48:51], v12 offset:2304
    ds_read_b128 v[52:55], v12 offset:2368
    ds_read_b128 v[56:59], v12 offset:2432
    ds_read_b128 v[60:63], v12 offset:2496
    s_waitcnt lgkmcnt(7)
    v_mfma_f32_16x16x32_bf16 v[108:111], v[224:227], v[80:83], v[108:111]
    v_mfma_f32_16x16x32_bf16 v[108:111], v[74:77], v[80:83], v[108:111]
    buffer_load_dwordx4 v[16:19], v2, s[16:19], 0 offen offset:0
    s_bitcmp1_b32 s97, 4
    s_cbranch_scc0 L_spin_26
L_ok_25:
    ds_read_b128 v[64:67], v12 offset:1536
    ds_read_b128 v[68:71], v12 offset:1600
    ds_read_b128 v[80:83], v12 offset:1664
    s_waitcnt lgkmcnt(9)
    v_mfma_f32_16x16x32_bf16 v[108:111], v[228:231], v[84:87], v[108:111]
    buffer_load_dwordx4 v[20:23], v2, s[16:19], 0 offen offset:1280
    ds_read_b128 v[84:87], v12 offset:1728
    s_waitcnt lgkmcnt(9)
    v_mfma_f32_16x16x32_bf16 v[108:111], v[232:235], v[88:91], v[108:111]
    buffer_load_dwordx4 v[24:27], v2, s[16:19], 0 offen offset:2560
    ds_read_b128 v[88:91], v12 offset:1792
    s_waitcnt lgkmcnt(9)
    v_mfma_f32_16x16x32_bf16 v[108:111], v[236:239], v[92:95], v[108:111]
    buffer_load_dwordx4 v[28:31], v2, s[16:19], 0 offen offset:3840
    ds_read_b128 v[92:95], v12 offset:1856
    s_waitcnt lgkmcnt(9)
    v_mfma_f32_16x16x32_bf16 v[108:111], v[240:243], v[48:51], v[108:111]
    buffer_load_dwordx4 v[32:35], v3, s[16:19], 0 offen offset:0
    ds_read_b128 v[48:51], v12 offset:1920
    s_waitcnt lgkmcnt(9)
    v_mfma_f32_16x16x32_bf16 v[108:111], v[244:247], v[52:55], v[108:111]
    buffer_load_dwordx4 v[36:39], v3, s[16:19], 0 offen offset:1280
    ds_read_b128 v[52:55], v12 offset:1984
    s_waitcnt lgkmcnt(9)
    v_mfma_f32_16x16x32_bf16 v[108:111], v[248:251], v[56:59], v[108:111]
    buffer_load_dwordx4 v[40:43], v3, s[16:19], 0 offen offset:2560
    s_waitcnt lgkmcnt(8)
    v_mfma_f32_16x16x32_bf16 v[108:111], v[252:255], v[60:63], v[108:111]
    buffer_load_dwordx4 v[44:47], v3, s[16:19], 0 offen offset:3840
    s_bitcmp1_b32 s97, 5
    s_cbranch_scc0 L_spin_28
L_ok_27:
    ds_read_b128 v[56:59], v12 offset:1024
    ds_read_b128 v[60:63], v12 offset:1088
    s_waitcnt lgkmcnt(9)
    v_mfma_f32_16x16x32_bf16 v[124:127], v[128:131], v[64:67], v[124:127]
    v_mfma_f32_16x16x32_bf16 v[120:123], v[160:163], v[64:67], v[120:123]
    v_mfma_f32_16x16x32_bf16 v[116:119], v[192:195], v[64:67], v[116:119]
    v_mfma_f32_16x16x32_bf16 v[112:115], v[224:227], v[64:67], v[112:115]
    v_mfma_f32_16x16x32_bf16 v[112:115], v[74:77], v[64:67], v[112:115]
    ds_read_b128 v[64:67], v12 offset:1152
    s_waitcnt lgkmcnt(9)
    v_mfma_f32_16x16x32_bf16 v[124:127], v[132:135], v[68:71], v[124:127]
    v_mfma_f32_16x16x32_bf16 v[120:123], v[164:167], v[68:71], v[120:123]
    v_mfma_f32_16x16x32_bf16 v[116:119], v[196:199], v[68:71], v[116:119]
    v_mfma_f32_16x16x32_bf16 v[112:115], v[228:231], v[68:71], v[112:115]
    v_cvt_pk_bf16_f32 v78, v108, v109
    v_cvt_pk_bf16_f32 v79, v110, v111
    ds_write_b64 v5, v[78:79] offset:1536
    ds_add_u32 v13, v14 offset:44
    ds_read_b128 v[68:71], v12 offset:1216
    s_waitcnt lgkmcnt(11)
    v_mfma_f32_16x16x32_bf16 v[124:127], v[136:139], v[80:83], v[124:127]
    v_mfma_f32_16x16x32_bf16 v[120:123], v[168:171], v[80:83], v[120:123]
    v_mfma_f32_16x16x32_bf16 v[116:119], v[200:203], v[80:83], v[116:119]
    v_mfma_f32_16x16x32_bf16 v[112:115], v[232:235], v[80:83], v[112:115]
    ds_read_b128 v[80:83], v12 offset:1280
    s_waitcnt lgkmcnt(11)
    v_mfma_f32_16x16x32_bf16 v[124:127], v[140:143], v[84:87], v[124:127]
    v_mfma_f32_16x16x32_bf16 v[120:123], v[172:175], v[84:87], v[120:123]
    v_mfma_f32_16x16x32_bf16 v[116:119], v[204:207], v[84:87], v[116:119]
    v_mfma_f32_16x16x32_bf16 v[112:115], v[236:239], v[84:87], v[112:115]
    ds_read_b128 v[84:87], v12 offset:1344
    s_waitcnt lgkmcnt(11)
    v_mfma_f32_16x16x32_bf16 v[124:127], v[144:147], v[88:91], v[124:127]
    v_mfma_f32_16x16x32_bf16 v[120:123], v[176:179], v[88:91], v[120:123]
    v_mfma_f32_16x16x32_bf16 v[116:119], v[208:211], v[88:91], v[116:119]
    v_mfma_f32_16x16x32_bf16 v[112:115], v[240:243], v[88:91], v[112:115]
    ds_read_b128 v[88:91], v12 offset:1408
    s_waitcnt lgkmcnt(11)
    v_mfma_f32_16x16x32_bf16 v[124:127], v[148:151], v[92:95], v[124:127]
    v_mfma_f32_16x16x32_bf16 v[120:123], v[180:183], v[92:95], v[120:123]
    v_mfma_f32_16x16x32_bf16 v[116:119], v[212:215], v[92:95], v[116:119]
    v_mfma_f32_16x16x32_bf16 v[112:115], v[244:247], v[92:95], v[112:115]
    ds_read_b128 v[92:95], v12 offset:1472
    s_waitcnt lgkmcnt(11)
    v_mfma_f32_16x16x32_bf16 v[124:127], v[152:155], v[48:51], v[124:127]
    v_mfma_f32_16x16x32_bf16 v[120:123], v[184:187], v[48:51], v[120:123]
    v_mfma_f32_16x16x32_bf16 v[116:119], v[216:219], v[48:51], v[116:119]
    v_mfma_f32_16x16x32_bf16 v[112:115], v[248:251], v[48:51], v[112:115]
    s_waitcnt lgkmcnt(10)
    v_mfma_f32_16x16x32_bf16 v[124:127], v[156:159], v[52:55], v[124:127]
    v_mfma_f32_16x16x32_bf16 v[120:123], v[188:191], v[52:55], v[120:123]
    v_mfma_f32_16x16x32_bf16 v[116:119], v[220:223], v[52:55], v[116:119]
    v_mfma_f32_16x16x32_bf16 v[112:115], v[252:255], v[52:55], v[112:115]
    s_waitcnt lgkmcnt(9)
    v_mfma_f32_16x16x32_bf16 v[124:127], v[160:163], v[56:59], v[124:127]
    v_mfma_f32_16x16x32_bf16 v[120:123], v[192:195], v[56:59], v[120:123]
    v_mfma_f32_16x16x32_bf16 v[116:119], v[224:227], v[56:59], v[116:119]
    v_mfma_f32_16x16x32_bf16 v[116:119], v[74:77], v[56:59], v[116:119]
    s_waitcnt lgkmcnt(8)
    v_mfma_f32_16x16x32_bf16 v[124:127], v[164:167], v[60:63], v[124:127]
    v_mfma_f32_16x16x32_bf16 v[120:123], v[196:199], v[60:63], v[120:123]
    v_mfma_f32_16x16x32_bf16 v[116:119], v[228:231], v[60:63], v[116:119]
    s_waitcnt lgkmcnt(7)
    v_mfma_f32_16x16x32_bf16 v[124:127], v[168:171], v[64:67], v[124:127]
    v_mfma_f32_16x16x32_bf16 v[120:123], v[200:203], v[64:67], v[120:123]
    v_cvt_pk_bf16_f32 v78, v112, v113
    v_cvt_pk_bf16_f32 v79, v114, v115
    ds_write_b64 v5, v[78:79] offset:2048
    ds_add_u32 v13, v14 offset:48
    v_mfma_f32_16x16x32_bf16 v[116:119], v[232:235], v[64:67], v[116:119]
    s_waitcnt lgkmcnt(6)
    v_mfma_f32_16x16x32_bf16 v[124:127], v[172:175], v[68:71], v[124:127]
    v_mfma_f32_16x16x32_bf16 v[120:123], v[204:207], v[68:71], v[120:123]
    v_mfma_f32_16x16x32_bf16 v[116:119], v[236:239], v[68:71], v[116:119]
    s_waitcnt lgkmcnt(5)
    v_mfma_f32_16x16x32_bf16 v[124:127], v[176:179], v[80:83], v[124:127]
    v_mfma_f32_16x16x32_bf16 v[120:123], v[208:211], v[80:83], v[120:123]
    v_mfma_f32_16x16x32_bf16 v[116:119], v[240:243], v[80:83], v[116:119]
    s_waitcnt lgkmcnt(4)
    v_mfma_f32_16x16x32_bf16 v[124:127], v[180:183], v[84:87], v[124:127]
    v_mfma_f32_16x16x32_bf16 v[120:123], v[212:215], v[84:87], v[120:123]
    v_mfma_f32_16x16x32_bf16 v[116:119], v[244:247], v[84:87], v[116:119]
    s_waitcnt lgkmcnt(3)
    v_mfma_f32_16x16x32_bf16 v[124:127], v[184:187], v[88:91], v[124:127]
    v_mfma_f32_16x16x32_bf16 v[120:123], v[216:219], v[88:91], v[120:123]
    v_mfma_f32_16x16x32_bf16 v[116:119], v[248:251], v[88:91], v[116:119]
    s_waitcnt lgkmcnt(2)
    v_mfma_f32_16x16x32_bf16 v[124:127], v[188:191], v[92:95], v[124:127]
    v_mfma_f32_16x16x32_bf16 v[120:123], v[220:223], v[92:95], v[120:123]
    v_mfma_f32_16x16x32_bf16 v[116:119], v[252:255], v[92:95], v[116:119]
    s_nop 7
    v_cvt_pk_bf16_f32 v78, v116, v117
    v_cvt_pk_bf16_f32 v79, v118, v119
    ds_write_b64 v5, v[78:79] offset:2560
    ds_add_u32 v13, v14 offset:52
    ds_read_b32 v15, v7 offset:16
    s_waitcnt lgkmcnt(0)
    v_readfirstlane_b32 s5, v15
    s_cmp_lt_u32 s5, 8
    s_cbranch_scc1 L_spin_30
L_ok_29:
    ds_read_b64 v[48:49], v6 offset:0
    ds_read_b64 v[50:51], v6 offset:4096
    ds_read_b64 v[52:53], v6 offset:8192
    ds_read_b64 v[54:55], v6 offset:12288
    ds_read_b64 v[56:57], v6 offset:16384
    ds_read_b64 v[58:59], v6 offset:20480
    ds_read_b64 v[60:61], v6 offset:24576
    ds_read_b64 v[62:63], v6 offset:28672
    v_lshlrev_b32 v2, 1, v2
    v_subrev_u32 v2, s6, v2
    s_waitcnt vmcnt(4)
    v_lshlrev_b32 v88, 16, v16
    v_and_b32 v89, 0xffff0000, v16
    v_lshlrev_b32 v90, 16, v20
    v_and_b32 v91, 0xffff0000, v20
    v_lshlrev_b32 v92, 16, v24
    v_and_b32 v93, 0xffff0000, v24
    v_lshlrev_b32 v94, 16, v28
    v_and_b32 v95, 0xffff0000, v28
    s_waitcnt lgkmcnt(6)
    v_lshlrev_b32 v80, 16, v48
    v_and_b32 v82, 0xffff0000, v48
    v_lshlrev_b32 v84, 16, v49
    v_and_b32 v86, 0xffff0000, v49
    v_lshlrev_b32 v81, 16, v50
    v_and_b32 v83, 0xffff0000, v50
    v_lshlrev_b32 v85, 16, v51
    v_and_b32 v87, 0xffff0000, v51
    v_pk_mul_f32 v[80:81], v[80:81], v[88:89]
    v_pk_mul_f32 v[82:83], v[82:83], v[90:91]
    v_pk_mul_f32 v[84:85], v[84:85], v[92:93]
    v_pk_mul_f32 v[86:87], v[86:87], v[94:95]
    v_cvt_pk_bf16_f32 v16, v80, v81
    v_cvt_pk_bf16_f32 v20, v82, v83
    v_cvt_pk_bf16_f32 v24, v84, v85
    v_cvt_pk_bf16_f32 v28, v86, v87
    v_lshlrev_b32 v88, 16, v17
    v_and_b32 v89, 0xffff0000, v17
    v_lshlrev_b32 v90, 16, v21
    v_and_b32 v91, 0xffff0000, v21
    v_lshlrev_b32 v92, 16, v25
    v_and_b32 v93, 0xffff0000, v25
    v_lshlrev_b32 v94, 16, v29
    v_and_b32 v95, 0xffff0000, v29
    s_waitcnt lgkmcnt(4)
    v_lshlrev_b32 v80, 16, v52
    v_and_b32 v82, 0xffff0000, v52
    v_lshlrev_b32 v84, 16, v53
    v_and_b32 v86, 0xffff0000, v53
    v_lshlrev_b32 v81, 16, v54
    v_and_b32 v83, 0xffff0000, v54
    v_lshlrev_b32 v85, 16, v55
    v_and_b32 v87, 0xffff0000, v55
    v_pk_mul_f32 v[80:81], v[80:81], v[88:89]
    v_pk_mul_f32 v[82:83], v[82:83], v[90:91]
    v_pk_mul_f32 v[84:85], v[84:85], v[92:93]
    v_pk_mul_f32 v[86:87], v[86:87], v[94:95]
    v_cvt_pk_bf16_f32 v17, v80, v81
    v_cvt_pk_bf16_f32 v21, v82, v83
    v_cvt_pk_bf16_f32 v25, v84, v85
    v_cvt_pk_bf16_f32 v29, v86, v87
    v_lshlrev_b32 v88, 16, v18
    v_and_b32 v89, 0xffff0000, v18
    v_lshlrev_b32 v90, 16, v22
    v_and_b32 v91, 0xffff0000, v22
    v_lshlrev_b32 v92, 16, v26
    v_and_b32 v93, 0xffff0000, v26
    v_lshlrev_b32 v94, 16, v30
    v_and_b32 v95, 0xffff0000, v30
    s_waitcnt lgkmcnt(2)
    v_lshlrev_b32 v80, 16, v56
    v_and_b32 v82, 0xffff0000, v56
    v_lshlrev_b32 v84, 16, v57
    v_and_b32 v86, 0xffff0000, v57
    v_lshlrev_b32 v81, 16, v58
    v_and_b32 v83, 0xffff0000, v58
    v_lshlrev_b32 v85, 16, v59
    v_and_b32 v87, 0xffff0000, v59
    v_pk_mul_f32 v[80:81], v[80:81], v[88:89]
    v_pk_mul_f32 v[82:83], v[82:83], v[90:91]
    v_pk_mul_f32 v[84:85], v[84:85], v[92:93]
    v_pk_mul_f32 v[86:87], v[86:87], v[94:95]
    v_cvt_pk_bf16_f32 v18, v80, v81
    v_cvt_pk_bf16_f32 v22, v82, v83
    v_cvt_pk_bf16_f32 v26, v84, v85
    v_cvt_pk_bf16_f32 v30, v86, v87
    v_lshlrev_b32 v88, 16, v19
    v_and_b32 v89, 0xffff0000, v19
    v_lshlrev_b32 v90, 16, v23
    v_and_b32 v91, 0xffff0000, v23
    v_lshlrev_b32 v92, 16, v27
    v_and_b32 v93, 0xffff0000, v27
    v_lshlrev_b32 v94, 16, v31
    v_and_b32 v95, 0xffff0000, v31
    s_waitcnt lgkmcnt(0)
    v_lshlrev_b32 v80, 16, v60
    v_and_b32 v82, 0xffff0000, v60
    v_lshlrev_b32 v84, 16, v61
    v_and_b32 v86, 0xffff0000, v61
    v_lshlrev_b32 v81, 16, v62
    v_and_b32 v83, 0xffff0000, v62
    v_lshlrev_b32 v85, 16, v63
    v_and_b32 v87, 0xffff0000, v63
    v_pk_mul_f32 v[80:81], v[80:81], v[88:89]
    v_pk_mul_f32 v[82:83], v[82:83], v[90:91]
    v_pk_mul_f32 v[84:85], v[84:85], v[92:93]
    v_pk_mul_f32 v[86:87], v[86:87], v[94:95]
    v_cvt_pk_bf16_f32 v19, v80, v81
    v_cvt_pk_bf16_f32 v23, v82, v83
    v_cvt_pk_bf16_f32 v27, v84, v85
    v_cvt_pk_bf16_f32 v31, v86, v87
    buffer_store_dwordx4 v[16:19], v2, s[24:27], 0 offen offset:0
    buffer_store_dwordx4 v[20:23], v2, s[24:27], 0 offen offset:2560
    v_add_u32 v2, 5120, v2
    buffer_store_dwordx4 v[24:27], v2, s[24:27], 0 offen offset:0
    buffer_store_dwordx4 v[28:31], v2, s[24:27], 0 offen offset:2560
    s_bitcmp1_b32 s97, 6
    s_cbranch_scc0 L_spin_32
L_ok_31:
    ds_read_b128 v[80:83], v12 offset:512
    ds_read_b128 v[84:87], v12 offset:576
    ds_read_b128 v[88:91], v12 offset:640
    ds_read_b128 v[92:95], v12 offset:704
    ds_read_b128 v[48:51], v12 offset:768
    ds_read_b128 v[52:55], v12 offset:832
    ds_read_b128 v[56:59], v12 offset:896
    ds_read_b128 v[60:63], v12 offset:960
    s_waitcnt lgkmcnt(7)
    v_mfma_f32_16x16x32_bf16 v[124:127], v[192:195], v[80:83], v[124:127]
    v_mfma_f32_16x16x32_bf16 v[120:123], v[224:227], v[80:83], v[120:123]
    v_mfma_f32_16x16x32_bf16 v[120:123], v[74:77], v[80:83], v[120:123]
    s_bitcmp1_b32 s97, 7
    s_cbranch_scc0 L_spin_34
L_ok_33:
    ds_read_b128 v[64:67], v12 offset:0
    ds_read_b128 v[68:71], v12 offset:64
    ds_read_b128 v[80:83], v12 offset:128
    s_waitcnt lgkmcnt(9)
    v_mfma_f32_16x16x32_bf16 v[124:127], v[196:199], v[84:87], v[124:127]
    v_mfma_f32_16x16x32_bf16 v[120:123], v[228:231], v[84:87], v[120:123]
    ds_read_b128 v[84:87], v12 offset:192
    s_waitcnt lgkmcnt(9)
    v_mfma_f32_16x16x32_bf16 v[124:127], v[200:203], v[88:91], v[124:127]
    v_mfma_f32_16x16x32_bf16 v[120:123], v[232:235], v[88:91], v[120:123]
    ds_read_b128 v[88:91], v12 offset:256
    s_waitcnt lgkmcnt(9)
    v_mfma_f32_16x16x32_bf16 v[124:127], v[204:207], v[92:95], v[124:127]
    v_mfma_f32_16x16x32_bf16 v[120:123], v[236:239], v[92:95], v[120:123]
    ds_read_b128 v[92:95], v12 offset:320
    s_waitcnt lgkmcnt(9)
    v_mfma_f32_16x16x32_bf16 v[124:127], v[208:211], v[48:51], v[124:127]
    v_mfma_f32_16x16x32_bf16 v[120:123], v[240:243], v[48:51], v[120:123]
    ds_read_b128 v[48:51], v12 offset:384
    s_waitcnt lgkmcnt(9)
    v_mfma_f32_16x16x32_bf16 v[124:127], v[212:215], v[52:55], v[124:127]
    v_mfma_f32_16x16x32_bf16 v[120:123], v[244:247], v[52:55], v[120:123]
    ds_read_b128 v[52:55], v12 offset:448
    s_waitcnt lgkmcnt(9)
    v_mfma_f32_16x16x32_bf16 v[124:127], v[216:219], v[56:59], v[124:127]
    v_mfma_f32_16x16x32_bf16 v[120:123], v[248:251], v[56:59], v[120:123]
    s_waitcnt lgkmcnt(8)
    v_mfma_f32_16x16x32_bf16 v[124:127], v[220:223], v[60:63], v[124:127]
    v_mfma_f32_16x16x32_bf16 v[120:123], v[252:255], v[60:63], v[120:123]
    s_waitcnt lgkmcnt(7)
    v_mfma_f32_16x16x32_bf16 v[124:127], v[224:227], v[64:67], v[124:127]
    v_mfma_f32_16x16x32_bf16 v[124:127], v[74:77], v[64:67], v[124:127]
    s_waitcnt lgkmcnt(6)
    v_mfma_f32_16x16x32_bf16 v[124:127], v[228:231], v[68:71], v[124:127]
    s_waitcnt lgkmcnt(5)
    v_mfma_f32_16x16x32_bf16 v[124:127], v[232:235], v[80:83], v[124:127]
    s_waitcnt lgkmcnt(4)
    v_mfma_f32_16x16x32_bf16 v[124:127], v[236:239], v[84:87], v[124:127]
    s_waitcnt lgkmcnt(3)
    v_mfma_f32_16x16x32_bf16 v[124:127], v[240:243], v[88:91], v[124:127]
    s_waitcnt lgkmcnt(2)
    v_mfma_f32_16x16x32_bf16 v[124:127], v[244:247], v[92:95], v[124:127]
    s_waitcnt lgkmcnt(1)
    v_mfma_f32_16x16x32_bf16 v[124:127], v[248:251], v[48:51], v[124:127]
    s_waitcnt lgkmcnt(0)
    v_mfma_f32_16x16x32_bf16 v[124:127], v[252:255], v[52:55], v[124:127]
    v_cvt_pk_bf16_f32 v78, v120, v121
    v_cvt_pk_bf16_f32 v79, v122, v123
    ds_write_b64 v5, v[78:79] offset:3072
    ds_add_u32 v13, v14 offset:56
    s_nop 7
    v_cvt_pk_bf16_f32 v78, v124, v125
    v_cvt_pk_bf16_f32 v79, v126, v127
    ds_write_b64 v5, v[78:79] offset:3584
    ds_add_u32 v13, v14 offset:60
    s_setprio 0
    ds_read_b32 v15, v7 offset:32
    s_waitcnt lgkmcnt(0)
    v_readfirstlane_b32 s5, v15
    s_cmp_lt_u32 s5, 8
    s_cbranch_scc1 L_spin_36
L_ok_35:
    ds_read_b64 v[48:49], v6 offset:2048
    ds_read_b64 v[50:51], v6 offset:6144
    ds_read_b64 v[52:53], v6 offset:10240
    ds_read_b64 v[54:55], v6 offset:14336
    ds_read_b64 v[56:57], v6 offset:18432
    ds_read_b64 v[58:59], v6 offset:22528
    ds_read_b64 v[60:61], v6 offset:26624
    ds_read_b64 v[62:63], v6 offset:30720
    v_lshlrev_b32 v2, 1, v3
    v_subrev_u32 v2, s6, v2
    s_waitcnt vmcnt(4)
    v_lshlrev_b32 v88, 16, v32
    v_and_b32 v89, 0xffff0000, v32
    v_lshlrev_b32 v90, 16, v36
    v_and_b32 v91, 0xffff0000, v36
    v_lshlrev_b32 v92, 16, v40
    v_and_b32 v93, 0xffff0000, v40
    v_lshlrev_b32 v94, 16, v44
    v_and_b32 v95, 0xffff0000, v44
    s_waitcnt lgkmcnt(6)
    v_lshlrev_b32 v80, 16, v48
    v_and_b32 v82, 0xffff0000, v48
    v_lshlrev_b32 v84, 16, v49
    v_and_b32 v86, 0xffff0000, v49
    v_lshlrev_b32 v81, 16, v50
    v_and_b32 v83, 0xffff0000, v50
    v_lshlrev_b32 v85, 16, v51
    v_and_b32 v87, 0xffff0000, v51
    v_pk_mul_f32 v[80:81], v[80:81], v[88:89]
    v_pk_mul_f32 v[82:83], v[82:83], v[90:91]
    v_pk_mul_f32 v[84:85], v[84:85], v[92:93]
    v_pk_mul_f32 v[86:87], v[86:87], v[94:95]
    v_cvt_pk_bf16_f32 v32, v80, v81
    v_cvt_pk_bf16_f32 v36, v82, v83
    v_cvt_pk_bf16_f32 v40, v84, v85
    v_cvt_pk_bf16_f32 v44, v86, v87
    v_lshlrev_b32 v88, 16, v33
    v_and_b32 v89, 0xffff0000, v33
    v_lshlrev_b32 v90, 16, v37
    v_and_b32 v91, 0xffff0000, v37
    v_lshlrev_b32 v92, 16, v41
    v_and_b32 v93, 0xffff0000, v41
    v_lshlrev_b32 v94, 16, v45
    v_and_b32 v95, 0xffff0000, v45
    s_waitcnt lgkmcnt(4)
    v_lshlrev_b32 v80, 16, v52
    v_and_b32 v82, 0xffff0000, v52
    v_lshlrev_b32 v84, 16, v53
    v_and_b32 v86, 0xffff0000, v53
    v_lshlrev_b32 v81, 16, v54
    v_and_b32 v83, 0xffff0000, v54
    v_lshlrev_b32 v85, 16, v55
    v_and_b32 v87, 0xffff0000, v55
    v_pk_mul_f32 v[80:81], v[80:81], v[88:89]
    v_pk_mul_f32 v[82:83], v[82:83], v[90:91]
    v_pk_mul_f32 v[84:85], v[84:85], v[92:93]
    v_pk_mul_f32 v[86:87], v[86:87], v[94:95]
    v_cvt_pk_bf16_f32 v33, v80, v81
    v_cvt_pk_bf16_f32 v37, v82, v83
    v_cvt_pk_bf16_f32 v41, v84, v85
    v_cvt_pk_bf16_f32 v45, v86, v87
    v_lshlrev_b32 v88, 16, v34
    v_and_b32 v89, 0xffff0000, v34
    v_lshlrev_b32 v90, 16, v38
    v_and_b32 v91, 0xffff0000, v38
    v_lshlrev_b32 v92, 16, v42
    v_and_b32 v93, 0xffff0000, v42
    v_lshlrev_b32 v94, 16, v46
    v_and_b32 v95, 0xffff0000, v46
    s_waitcnt lgkmcnt(2)
    v_lshlrev_b32 v80, 16, v56
    v_and_b32 v82, 0xffff0000, v56
    v_lshlrev_b32 v84, 16, v57
    v_and_b32 v86, 0xffff0000, v57
    v_lshlrev_b32 v81, 16, v58
    v_and_b32 v83, 0xffff0000, v58
    v_lshlrev_b32 v85, 16, v59
    v_and_b32 v87, 0xffff0000, v59
    v_pk_mul_f32 v[80:81], v[80:81], v[88:89]
    v_pk_mul_f32 v[82:83], v[82:83], v[90:91]
    v_pk_mul_f32 v[84:85], v[84:85], v[92:93]
    v_pk_mul_f32 v[86:87], v[86:87], v[94:95]
    v_cvt_pk_bf16_f32 v34, v80, v81
    v_cvt_pk_bf16_f32 v38, v82, v83
    v_cvt_pk_bf16_f32 v42, v84, v85
    v_cvt_pk_bf16_f32 v46, v86, v87
    v_lshlrev_b32 v88, 16, v35
    v_and_b32 v89, 0xffff0000, v35
    v_lshlrev_b32 v90, 16, v39
    v_and_b32 v91, 0xffff0000, v39
    v_lshlrev_b32 v92, 16, v43
    v_and_b32 v93, 0xffff0000, v43
    v_lshlrev_b32 v94, 16, v47
    v_and_b32 v95, 0xffff0000, v47
    s_waitcnt lgkmcnt(0)
    v_lshlrev_b32 v80, 16, v60
    v_and_b32 v82, 0xffff0000, v60
    v_lshlrev_b32 v84, 16, v61
    v_and_b32 v86, 0xffff0000, v61
    v_lshlrev_b32 v81, 16, v62
    v_and_b32 v83, 0xffff0000, v62
    v_lshlrev_b32 v85, 16, v63
    v_and_b32 v87, 0xffff0000, v63
    v_pk_mul_f32 v[80:81], v[80:81], v[88:89]
    v_pk_mul_f32 v[82:83], v[82:83], v[90:91]
    v_pk_mul_f32 v[84:85], v[84:85], v[92:93]
    v_pk_mul_f32 v[86:87], v[86:87], v[94:95]
    v_cvt_pk_bf16_f32 v35, v80, v81
    v_cvt_pk_bf16_f32 v39, v82, v83
    v_cvt_pk_bf16_f32 v43, v84, v85
    v_cvt_pk_bf16_f32 v47, v86, v87
    buffer_store_dwordx4 v[32:35], v2, s[24:27], 0 offen offset:0
    buffer_store_dwordx4 v[36:39], v2, s[24:27], 0 offen offset:2560
    v_add_u32 v2, 5120, v2
    buffer_store_dwordx4 v[40:43], v2, s[24:27], 0 offen offset:0
    buffer_store_dwordx4 v[44:47], v2, s[24:27], 0 offen offset:2560
    s_endpgm
L_B:
    s_sub_u32 s6, s6, s68
    s_lshr_b32 s71, s6, 3
    s_add_u32 s71, s71, s67
    s_and_b32 s72, s6, 7
    s_lshl_b32 s71, s71, 5
    s_lshl_b32 s72, s72, 2
    s_add_u32 s3, s71, s72
    s_lshr_b32 s64, s4, 1
    s_and_b32 s65, s4, 1
    s_add_u32 s5, s3, s64
    s_lshl_b32 s5, s5, 8
    s_lshl_b32 s71, s65, 7
    s_add_u32 s5, s5, s71
    v_lshlrev_b32 v2, 1, v1
    v_add_u32 v2, s5, v2
    global_load_ushort v16, v2, s[46:47]
    global_load_ushort v17, v2, s[48:49]
    global_load_ushort v18, v2, s[50:51]
    global_load_ushort v19, v2, s[52:53]
    global_load_ushort v20, v2, s[54:55]
    global_load_ushort v21, v2, s[56:57]
    s_lshl_b32 s5, s3, 1
    s_load_dwordx2 s[88:89], s[58:59], s5
    s_load_dwordx2 s[90:91], s[60:61], s5
    s_barrier
    s_lshl_b32 s71, s7, 1
    s_cmp_eq_u32 s71, 4
    s_movk_i32 s73, 10923
    s_cselect_b32 s73, 16384, s73
    s_lshl_b32 s74, s6, 2
    s_and_b32 s75, s4, 3
    s_add_u32 s74, s74, s75
    s_lshl_b32 s75, s69, 5
    s_lshl_b32 s76, s71, 4
    s_mov_b32 s81, 0
    v_mul_u32_u24 v229, 1280, v1
    s_mov_b32 s77, s74
    s_mul_i32 s78, s77, s73
    s_lshr_b32 s78, s78, 16
    s_mul_i32 s79, s78, s71
    s_sub_u32 s79, s77, s79
    s_add_u32 s78, s78, s81
    s_and_b32 s80, s79, 1
    s_lshr_b32 s79, s79, 1
    s_add_u32 s79, s79, s66
    s_cmp_eq_u32 s80, 0
    s_cselect_b32 s12, s34, s36
    s_cselect_b32 s13, s35, s37
    s_mov_b32 s14, 2621440
    s_mov_b32 s15, 0x00020000
    s_lshl_b32 s79, s79, 6
    s_mul_i32 s78, s78, 81920
    s_add_u32 s78, s78, s79
    s_cmp_ge_u32 s77, s76
    s_cselect_b32 s94, 0x70000000, s78
    s_lshl_b32 s78, s77, 1
    s_mul_i32 s78, s78, s73
    s_lshr_b32 s78, s78, 16
    s_mul_i32 s79, s78, s7
    s_sub_u32 s79, s77, s79
    s_add_u32 s79, s79, s66
    s_lshl_b32 s79, s79, 6
    s_mul_i32 s78, s78, 81920
    s_add_u32 s78, s78, s79
    s_cmp_ge_u32 s77, s76
    s_cselect_b32 s28, 0x70000000, s78
    s_add_u32 s77, s74, s75
    s_mul_i32 s78, s77, s73
    s_lshr_b32 s78, s78, 16
    s_mul_i32 s79, s78, s71
    s_sub_u32 s79, s77, s79
    s_add_u32 s78, s78, s81
    s_and_b32 s80, s79, 1
    s_lshr_b32 s79, s79, 1
    s_add_u32 s79, s79, s66
    s_cmp_eq_u32 s80, 0
    s_cselect_b32 s16, s34, s36
    s_cselect_b32 s17, s35, s37
    s_mov_b32 s18, 2621440
    s_mov_b32 s19, 0x00020000
    s_lshl_b32 s79, s79, 6
    s_mul_i32 s78, s78, 81920
    s_add_u32 s78, s78, s79
    s_cmp_ge_u32 s77, s76
    s_cselect_b32 s95, 0x70000000, s78
    s_lshl_b32 s78, s77, 1
    s_mul_i32 s78, s78, s73
    s_lshr_b32 s78, s78, 16
    s_mul_i32 s79, s78, s7
    s_sub_u32 s79, s77, s79
    s_add_u32 s79, s79, s66
    s_lshl_b32 s79, s79, 6
    s_mul_i32 s78, s78, 81920
    s_add_u32 s78, s78, s79
    s_cmp_ge_u32 s77, s76
    s_cselect_b32 s29, 0x70000000, s78
    s_mov_b32 s20, s32
    s_mov_b32 s21, s33
    s_mov_b32 s22, 2621440
    s_mov_b32 s23, 0x00020000
    s_mov_b32 m0, 128
    s_cmp_lt_u32 s4, 4
    s_cbranch_scc1 L_B_nopf0
    buffer_load_dword v229, s[12:15], s94 offen lds
    buffer_load_dword v229, s[16:19], s95 offen lds
L_B_nopf0:
    s_lshl_b32 s6, s3, 1
    s_mov_b32 s8, s44
    s_mov_b32 s9, s45
    s_mov_b32 s10, 2621440
    s_mov_b32 s11, 0x00020000
    s_mov_b32 s24, s62
    s_mov_b32 s25, s63
    s_mov_b32 s26, 5242880
    s_mov_b32 s27, 0x00020000
    s_cmp_lt_u32 s4, 4
    s_cbranch_scc1 L_B_nopf1
    s_lshr_b32 s5, s3, 2
    s_and_b32 s5, s5, 7
    s_lshl_b32 s5, s5, 2
    s_add_u32 s5, s5, s4
    s_sub_u32 s5, s5, 4
    s_mul_i32 s5, s5, 81920
    s_add_u32 s5, s5, s6
    buffer_load_dword v229, s[8:11], s5 offen lds
    s_add_u32 s94, s94, 1310720
    buffer_load_dword v229, s[12:15], s94 offen lds
    s_add_u32 s95, s95, 1310720
    buffer_load_dword v229, s[16:19], s95 offen lds
L_B_nopf1:
    s_mul_i32 s7, s4, 327680
    s_add_u32 s7, s7, s6
    v_mul_u32_u24 v3, 5120, v1
    v_add_u32 v3, s7, v3
    s_mov_b32 s93, 1310720
    s_mul_i32 s84, s64, 16640
    s_add_u32 s84, s84, 640
    s_mul_i32 s85, s64, 4608
    s_add_u32 s85, s85, 67200
    s_mul_i32 s86, s4, 8704
    s_add_u32 s86, s86, 85632
    s_mul_i32 s87, s64, 17408
    s_add_u32 s87, s87, 85632
    v_mov_b32 v6, 0
    v_mov_b32 v7, 0
    v_lshlrev_b32 v24, 3, v1
    v_add_u32 v24, s85, v24
    ds_write_b64 v24, v[6:7] offset:4096
    v_and_b32 v24, 15, v1
    v_lshrrev_b32 v25, 4, v1
    v_add_u32 v26, 1, v24
    v_lshrrev_b32 v26, 2, v26
    v_lshl_add_u32 v26, v25, 1, v26
    v_lshlrev_b32 v26, 3, v26
    v_add_u32 v27, 1, v24
    v_and_b32 v27, 3, v27
    v_mul_u32_u24 v27, 4160, v27
    v_add3_u32 v8, v26, v27, s84
    v_lshlrev_b32 v26, 5, v24
    v_lshlrev_b32 v27, 4, v25
    v_sub_u32 v27, v27, v26
    v_add_u32 v27, 480, v27
    v_add_u32 v12, s85, v27
    s_lshl_b32 s5, s65, 10
    v_lshlrev_b32 v24, 3, v1
    s_cmp_lg_u32 s65, 0
    s_cbranch_scc1 L_B_ga1
    v_cvt_f32_u32 v25, v24
    s_movk_i32 s71, 127
    v_add_f32 v26, 0x0, v25
    v_add_f32 v27, 0x3f800000, v25
    v_cvt_pk_bf16_f32 v26, v26, v27
    v_and_b32 v232, 0xffff, v26
    v_subrev_u32 v232, 17024, v232
    v_add_u32 v27, 0, v24
    v_med3_i32 v232, v232, v27, s71
    v_lshrrev_b32 v27, 3, v232
    v_add_u32 v232, v232, v27
    v_lshl_add_u32 v232, v232, 2, s87
    v_lshrrev_b32 v233, 16, v26
    v_subrev_u32 v233, 17024, v233
    v_add_u32 v27, 1, v24
    v_med3_i32 v233, v233, v27, s71
    v_lshrrev_b32 v27, 3, v233
    v_add_u32 v233, v233, v27
    v_lshl_add_u32 v233, v233, 2, s87
    v_add_f32 v26, 0x40000000, v25
    v_add_f32 v27, 0x40400000, v25
    v_cvt_pk_bf16_f32 v26, v26, v27
    v_and_b32 v234, 0xffff, v26
    v_subrev_u32 v234, 17024, v234
    v_add_u32 v27, 2, v24
    v_med3_i32 v234, v234, v27, s71
    v_lshrrev_b32 v27, 3, v234
    v_add_u32 v234, v234, v27
    v_lshl_add_u32 v234, v234, 2, s87
    v_lshrrev_b32 v235, 16, v26
    v_subrev_u32 v235, 17024, v235
    v_add_u32 v27, 3, v24
    v_med3_i32 v235, v235, v27, s71
    v_lshrrev_b32 v27, 3, v235
    v_add_u32 v235, v235, v27
    v_lshl_add_u32 v235, v235, 2, s87
    v_add_f32 v26, 0x40800000, v25
    v_add_f32 v27, 0x40a00000, v25
    v_cvt_pk_bf16_f32 v26, v26, v27
    v_and_b32 v236, 0xffff, v26
    v_subrev_u32 v236, 17024, v236
    v_add_u32 v27, 4, v24
    v_med3_i32 v236, v236, v27, s71
    v_lshrrev_b32 v27, 3, v236
    v_add_u32 v236, v236, v27
    v_lshl_add_u32 v236, v236, 2, s87
    v_lshrrev_b32 v237, 16, v26
    v_subrev_u32 v237, 17024, v237
    v_add_u32 v27, 5, v24
    v_med3_i32 v237, v237, v27, s71
    v_lshrrev_b32 v27, 3, v237
    v_add_u32 v237, v237, v27
    v_lshl_add_u32 v237, v237, 2, s87
    v_add_f32 v26, 0x40c00000, v25
    v_add_f32 v27, 0x40e00000, v25
    v_cvt_pk_bf16_f32 v26, v26, v27
    v_and_b32 v238, 0xffff, v26
    v_subrev_u32 v238, 17024, v238
    v_add_u32 v27, 6, v24
    v_med3_i32 v238, v238, v27, s71
    v_lshrrev_b32 v27, 3, v238
    v_add_u32 v238, v238, v27
    v_lshl_add_u32 v238, v238, 2, s87
    v_lshrrev_b32 v239, 16, v26
    v_subrev_u32 v239, 17024, v239
    v_add_u32 v27, 7, v24
    v_med3_i32 v239, v239, v27, s71
    v_lshrrev_b32 v27, 3, v239
    v_add_u32 v239, v239, v27
    v_lshl_add_u32 v239, v239, 2, s87
    v_add_f32 v26, 0x41000000, v25
    v_add_f32 v27, 0x41100000, v25
    v_cvt_pk_bf16_f32 v26, v26, v27
    v_and_b32 v240, 0xffff, v26
    v_subrev_u32 v240, 17024, v240
    v_add_u32 v27, 8, v24
    v_med3_i32 v240, v240, v27, s71
    v_lshrrev_b32 v27, 3, v240
    v_add_u32 v240, v240, v27
    v_lshl_add_u32 v240, v240, 2, s87
    v_lshrrev_b32 v241, 16, v26
    v_subrev_u32 v241, 17024, v241
    v_add_u32 v27, 9, v24
    v_med3_i32 v241, v241, v27, s71
    v_lshrrev_b32 v27, 3, v241
    v_add_u32 v241, v241, v27
    v_lshl_add_u32 v241, v241, 2, s87
    v_add_f32 v26, 0x41200000, v25
    v_add_f32 v27, 0x41300000, v25
    v_cvt_pk_bf16_f32 v26, v26, v27
    v_and_b32 v242, 0xffff, v26
    v_subrev_u32 v242, 17024, v242
    v_add_u32 v27, 10, v24
    v_med3_i32 v242, v242, v27, s71
    v_lshrrev_b32 v27, 3, v242
    v_add_u32 v242, v242, v27
    v_lshl_add_u32 v242, v242, 2, s87
    v_lshlrev_b32 v25, 1, v1
    v_add_u32 v243, 384, v25
    v_lshrrev_b32 v27, 3, v243
    v_add_u32 v243, v243, v27
    v_lshl_add_u32 v243, v243, 2, s87
    v_add_u32 v244, 385, v25
    v_lshrrev_b32 v27, 3, v244
    v_add_u32 v244, v244, v27
    v_lshl_add_u32 v244, v244, 2, s87
    v_add_u32 v245, 386, v25
    v_lshrrev_b32 v27, 3, v245
    v_add_u32 v245, v245, v27
    v_lshl_add_u32 v245, v245, 2, s87
    s_branch L_B_ga2
L_B_ga1:
    v_and_b32 v25, 1, v1
    v_add_u32 v25, v25, v1
    v_add_u32 v232, 512, v1
    v_add_u32 v233, 513, v1
    v_add_u32 v234, 512, v25
    v_lshrrev_b32 v27, 3, v232
    v_add_u32 v232, v232, v27
    v_lshl_add_u32 v232, v232, 2, s87
    v_lshrrev_b32 v27, 3, v233
    v_add_u32 v233, v233, v27
    v_lshl_add_u32 v233, v233, 2, s87
    v_lshrrev_b32 v27, 3, v234
    v_add_u32 v234, v234, v27
    v_lshl_add_u32 v234, v234, 2, s87
    v_add_u32 v235, 576, v1
    v_add_u32 v236, 577, v1
    v_add_u32 v237, 576, v25
    v_lshrrev_b32 v27, 3, v235
    v_add_u32 v235, v235, v27
    v_lshl_add_u32 v235, v235, 2, s87
    v_lshrrev_b32 v27, 3, v236
    v_add_u32 v236, v236, v27
    v_lshl_add_u32 v236, v236, 2, s87
    v_lshrrev_b32 v27, 3, v237
    v_add_u32 v237, v237, v27
    v_lshl_add_u32 v237, v237, 2, s87
L_B_ga2:
    v_add_u32 v24, s5, v24
    v_lshlrev_b32 v250, 1, v24
    v_add_u32 v250, s84, v250
    v_lshlrev_b32 v216, 2, v1
    v_add_u32 v216, s86, v216
    v_add_u32 v217, 1088, v216
    v_add_u32 v218, 2176, v216
    v_add_u32 v219, 3264, v216
    v_add_u32 v220, 4352, v216
    v_add_u32 v221, 5440, v216
    v_add_u32 v222, 6528, v216
    v_add_u32 v223, 7616, v216
    v_and_b32 v24, 15, v1
    v_lshrrev_b32 v25, 4, v1
    v_mul_u32_u24 v224, 544, v24
    v_lshl_add_u32 v224, v25, 4, v224
    v_add_u32 v224, s86, v224
    s_mov_b32 s5, s86
    v_lshrrev_b32 v225, 1, v25
    v_lshlrev_b32 v225, 7, v225
    v_and_b32 v26, 1, v25
    v_lshl_add_u32 v225, v26, 2, v225
    v_lshl_add_u32 v225, v24, 3, v225
    v_lshrrev_b32 v28, 3, v225
    v_add_u32 v225, v225, v28
    v_lshl_add_u32 v225, v225, 2, s5
    v_lshlrev_b32 v226, 6, v25
    v_add_u32 v226, 256, v226
    v_cmp_gt_u32 vcc, 2, v25
    v_lshlrev_b32 v26, 2, v24
    v_lshlrev_b32 v27, 1, v24
    v_cndmask_b32 v26, v27, v26, vcc
    v_add_u32 v226, v226, v26
    v_lshrrev_b32 v28, 3, v226
    v_add_u32 v226, v226, v28
    v_lshl_add_u32 v226, v226, 2, s5
    v_mov_b32 v26, 144
    v_cndmask_b32_e64 v26, v26, 8, vcc
    v_add_u32 v227, v226, v26
    v_lshl_add_u32 v228, v25, 6, v24
    v_add_u32 v228, 512, v228
    v_lshrrev_b32 v28, 3, v228
    v_add_u32 v228, v228, v28
    v_lshl_add_u32 v228, v228, 2, s5
    s_lshl_b32 s5, s4, 9
    s_sub_u32 s5, 69240, s5
    v_lshlrev_b32 v4, 3, v1
    v_sub_u32 v4, s5, v4
    s_lshl_b32 s5, s64, 2
    v_add_u32 v2, s5, v13
    s_lshl_b32 s5, s4, 2
    v_add_u32 v5, s5, v13
    s_waitcnt lgkmcnt(0)
    s_lshr_b32 s5, s64, 1
    s_cmp_eq_u32 s5, 0
    s_cselect_b32 s66, s88, s89
    s_cselect_b32 s92, s90, s91
    s_and_b32 s5, s64, 1
    s_lshl_b32 s5, s5, 4
    s_lshr_b32 s66, s66, s5
    s_lshl_b32 s66, s66, 16
    s_lshr_b32 s92, s92, s5
    s_and_b32 s92, s92, 0xffff
    s_mov_b32 s68, 0x3fb8aa3b
    s_mov_b32 s69, 0x32a57060
    s_mov_b32 s70, 0x3f317218
    s_mov_b32 s71, 0x3e22f983
    s_mov_b32 s72, 0x31dc9c88
    v_mov_b32 v24, s66
    v_mul_f32 v25, s68, v24
    v_fma_f32 v26, v24, s68, -v25
    v_fmac_f32 v26, s69, v24
    v_exp_f32 v27, v25
    v_mul_f32 v26, s70, v26
    s_nop 0
    v_fma_f32 v27, v27, v26, v27
    v_cvt_pk_bf16_f32 v27, v27, v27
    v_lshlrev_b32 v27, 16, v27
    s_cmp_lt_u32 s4, 4
    s_cbranch_scc1 L_B_w0
    s_waitcnt vmcnt(5)
    s_branch L_B_w1
L_B_w0:
    s_waitcnt vmcnt(0)
L_B_w1:
    v_lshlrev_b32 v16, 16, v16
    v_lshlrev_b32 v17, 16, v17
    v_lshlrev_b32 v18, 16, v18
    v_lshlrev_b32 v19, 16, v19
    v_lshlrev_b32 v20, 16, v20
    v_lshlrev_b32 v21, 16, v21
    v_mul_f32 v16, v27, v16
    v_mul_f32 v17, v27, v17
    v_mul_f32 v18, v27, v18
    v_mul_f32 v19, v27, v19
    s_mov_b32 s80, 0x0000bf80
    s_mov_b32 s81, 0xbf800000
    s_mov_b32 s73, 0x41000000
    s_mov_b32 s74, 0x42800000
    s_mov_b32 s75, 0x3f800000
    s_mov_b32 s76, 0x43000000
    s_mov_b32 s77, 0x44800000
    v_mul_f32 v138, s73, v16
    v_mul_f32 v142, s74, v16
    v_mul_f32 v146, s75, v16
    v_mul_f32 v150, s76, v16
    v_mul_f32 v154, s77, v16
    v_pk_mul_f32 v[158:159], v[20:21], v[18:19] op_sel:[0,0] op_sel_hi:[1,0]
    v_mul_f32 v139, s73, v17
    v_mul_f32 v143, s74, v17
    v_mul_f32 v147, s75, v17
    v_mul_f32 v151, s76, v17
    v_mul_f32 v155, s77, v17
    v_pk_fma_f32 v[96:97], v[20:21], v[18:19], v[158:159] op_sel:[1,1,0] op_sel_hi:[0,1,1] neg_lo:[1,0,0]
    v_mul_f32 v138, s68, v138
    v_mul_f32 v142, s68, v142
    v_mul_f32 v146, s68, v146
    v_mul_f32 v150, s68, v150
    v_mul_f32 v154, s68, v154
    v_mul_f32 v140, s71, v139
    v_mul_f32 v144, s71, v143
    v_mul_f32 v148, s71, v147
    v_mul_f32 v152, s71, v151
    v_mul_f32 v156, s71, v155
    v_exp_f32 v138, v138
    v_exp_f32 v142, v142
    v_exp_f32 v146, v146
    v_exp_f32 v150, v150
    v_exp_f32 v154, v154
    v_fma_f32 v141, v139, s71, -v140
    v_fma_f32 v145, v143, s71, -v144
    v_fma_f32 v149, v147, s71, -v148
    v_fma_f32 v153, v151, s71, -v152
    v_fma_f32 v157, v155, s71, -v156
    v_fmac_f32 v141, s72, v139
    v_fmac_f32 v145, s72, v143
    v_fmac_f32 v149, s72, v147
    v_fmac_f32 v153, s72, v151
    v_fmac_f32 v157, s72, v155
    v_fract_f32 v140, v140
    v_fract_f32 v144, v144
    v_fract_f32 v148, v148
    v_fract_f32 v152, v152
    v_fract_f32 v156, v156
    v_add_f32 v140, v140, v141
    v_add_f32 v144, v144, v145
    v_add_f32 v148, v148, v149
    v_add_f32 v152, v152, v153
    v_add_f32 v156, v156, v157
    v_cos_f32 v139, v140
    v_cos_f32 v143, v144
    v_cos_f32 v147, v148
    v_cos_f32 v151, v152
    v_cos_f32 v155, v156
    v_sin_f32 v141, v140
    v_sin_f32 v145, v144
    v_sin_f32 v149, v148
    v_sin_f32 v153, v152
    v_sin_f32 v157, v156
    v_mul_f32 v50, v138, v139
    v_mul_f32 v64, v142, v143
    v_mul_f32 v82, v146, v147
    v_mul_f32 v130, v150, v151
    v_mul_f32 v136, v154, v155
    v_mul_f32_e64 v51, -v138, v141
    v_mul_f32_e64 v65, -v142, v145
    v_mul_f32 v83, v146, v149
    v_mul_f32 v131, v150, v153
    v_mul_f32 v137, v154, v157
    v_max_f32_e64 v138, abs(v96), abs(v97)
    v_cmp_lt_f32 vcc, 0, v16
    s_nop 0
    v_max_f32_dpp v138, v138, v138 row_shr:1 row_mask:0xf bank_mask:0xf
    s_nop 1
    v_max_f32_dpp v138, v138, v138 row_shr:2 row_mask:0xf bank_mask:0xf
    s_nop 1
    v_max_f32_dpp v138, v138, v138 row_shr:4 row_mask:0xf bank_mask:0xf
    s_nop 1
    v_max_f32_dpp v138, v138, v138 row_shr:8 row_mask:0xf bank_mask:0xf
    s_nop 1
    v_max_f32_dpp v138, v138, v138 row_bcast:15 row_mask:0xa bank_mask:0xf
    s_nop 1
    v_max_f32_dpp v138, v138, v138 row_bcast:31 row_mask:0xc bank_mask:0xf
    s_nop 1
    v_readlane_b32 s5, v138, 63
    s_or_b32 s83, vcc_lo, vcc_hi
    v_mov_b32 v48, 1.0
    v_mov_b32 v49, 0
    s_lshr_b32 s5, s5, 23
    s_max_u32 s5, s5, 1
    s_min_u32 s5, s5, 252
    s_sub_u32 s82, 253, s5
    s_lshl_b32 s82, s82, 23
    s_add_u32 s5, s5, 1
    s_lshl_b32 s77, s5, 23
    v_mul_f32 v96, s82, v96
    v_mul_f32 v97, s82, v97
    v_pk_mul_f32 v[138:139], v[50:51], v[50:51] op_sel:[0,0] op_sel_hi:[1,0]
    v_pk_mul_f32 v[140:141], v[82:83], v[82:83] op_sel:[0,0] op_sel_hi:[1,0]
    v_pk_mul_f32 v[142:143], v[130:131], v[130:131] op_sel:[0,0] op_sel_hi:[1,0]
    v_pk_mul_f32 v[144:145], v[96:97], v[130:131] op_sel:[0,0] op_sel_hi:[1,0]
    v_pk_mul_f32 v[146:147], v[64:65], v[50:51] op_sel:[0,0] op_sel_hi:[1,0]
    v_pk_mul_f32 v[148:149], v[96:97], v[136:137] op_sel:[0,0] op_sel_hi:[1,0]
    v_pk_fma_f32 v[52:53], v[50:51], v[50:51], v[138:139] op_sel:[1,1,0] op_sel_hi:[0,1,1] neg_lo:[1,0,0]
    v_pk_fma_f32 v[84:85], v[82:83], v[82:83], v[140:141] op_sel:[1,1,0] op_sel_hi:[0,1,1] neg_lo:[1,0,0]
    v_pk_fma_f32 v[132:133], v[130:131], v[130:131], v[142:143] op_sel:[1,1,0] op_sel_hi:[0,1,1] neg_lo:[1,0,0]
    v_pk_fma_f32 v[98:99], v[96:97], v[130:131], v[144:145] op_sel:[1,1,0] op_sel_hi:[0,1,1] neg_lo:[1,0,0]
    v_pk_fma_f32 v[66:67], v[64:65], v[50:51], v[146:147] op_sel:[1,1,0] op_sel_hi:[0,1,1] neg_lo:[1,0,0]
    v_pk_fma_f32 v[112:113], v[96:97], v[136:137], v[148:149] op_sel:[1,1,0] op_sel_hi:[0,1,1] neg_lo:[1,0,0]
    v_pk_mul_f32 v[138:139], v[52:53], v[50:51] op_sel:[0,0] op_sel_hi:[1,0]
    v_pk_mul_f32 v[140:141], v[52:53], v[52:53] op_sel:[0,0] op_sel_hi:[1,0]
    v_pk_mul_f32 v[142:143], v[84:85], v[82:83] op_sel:[0,0] op_sel_hi:[1,0]
    v_pk_mul_f32 v[144:145], v[84:85], v[84:85] op_sel:[0,0] op_sel_hi:[1,0]
    v_pk_mul_f32 v[146:147], v[132:133], v[132:133] op_sel:[0,0] op_sel_hi:[1,0]
    v_pk_mul_f32 v[148:149], v[96:97], v[132:133] op_sel:[0,0] op_sel_hi:[1,0]
    v_pk_mul_f32 v[150:151], v[98:99], v[132:133] op_sel:[0,0] op_sel_hi:[1,0]
    v_pk_mul_f32 v[152:153], v[64:65], v[52:53] op_sel:[0,0] op_sel_hi:[1,0]
    v_pk_mul_f32 v[154:155], v[98:99], v[136:137] op_sel:[0,0] op_sel_hi:[1,0]
    v_pk_mul_f32 v[156:157], v[112:113], v[136:137] op_sel:[0,0] op_sel_hi:[1,0]
    v_pk_fma_f32 v[54:55], v[52:53], v[50:51], v[138:139] op_sel:[1,1,0] op_sel_hi:[0,1,1] neg_lo:[1,0,0]
    v_pk_fma_f32 v[56:57], v[52:53], v[52:53], v[140:141] op_sel:[1,1,0] op_sel_hi:[0,1,1] neg_lo:[1,0,0]
    v_pk_fma_f32 v[86:87], v[84:85], v[82:83], v[142:143] op_sel:[1,1,0] op_sel_hi:[0,1,1] neg_lo:[1,0,0]
    v_pk_fma_f32 v[88:89], v[84:85], v[84:85], v[144:145] op_sel:[1,1,0] op_sel_hi:[0,1,1] neg_lo:[1,0,0]
    v_pk_fma_f32 v[134:135], v[132:133], v[132:133], v[146:147] op_sel:[1,1,0] op_sel_hi:[0,1,1] neg_lo:[1,0,0]
    v_pk_fma_f32 v[100:101], v[96:97], v[132:133], v[148:149] op_sel:[1,1,0] op_sel_hi:[0,1,1] neg_lo:[1,0,0]
    v_pk_fma_f32 v[102:103], v[98:99], v[132:133], v[150:151] op_sel:[1,1,0] op_sel_hi:[0,1,1] neg_lo:[1,0,0]
    v_pk_fma_f32 v[68:69], v[64:65], v[52:53], v[152:153] op_sel:[1,1,0] op_sel_hi:[0,1,1] neg_lo:[1,0,0]
    v_pk_fma_f32 v[114:115], v[98:99], v[136:137], v[154:155] op_sel:[1,1,0] op_sel_hi:[0,1,1] neg_lo:[1,0,0]
    v_pk_fma_f32 v[128:129], v[112:113], v[136:137], v[156:157] op_sel:[1,1,0] op_sel_hi:[0,1,1] neg_lo:[1,0,0]
    v_pk_mul_f32 v[138:139], v[56:57], v[50:51] op_sel:[0,0] op_sel_hi:[1,0]
    v_pk_mul_f32 v[140:141], v[56:57], v[52:53] op_sel:[0,0] op_sel_hi:[1,0]
    v_pk_mul_f32 v[142:143], v[56:57], v[54:55] op_sel:[0,0] op_sel_hi:[1,0]
    v_pk_mul_f32 v[144:145], v[64:65], v[54:55] op_sel:[0,0] op_sel_hi:[1,0]
    v_pk_mul_f32 v[146:147], v[64:65], v[56:57] op_sel:[0,0] op_sel_hi:[1,0]
    v_pk_mul_f32 v[148:149], v[88:89], v[82:83] op_sel:[0,0] op_sel_hi:[1,0]
    v_pk_mul_f32 v[150:151], v[88:89], v[84:85] op_sel:[0,0] op_sel_hi:[1,0]
    v_pk_mul_f32 v[152:153], v[88:89], v[86:87] op_sel:[0,0] op_sel_hi:[1,0]
    v_pk_mul_f32 v[154:155], v[96:97], v[134:135] op_sel:[0,0] op_sel_hi:[1,0]
    v_pk_mul_f32 v[156:157], v[98:99], v[134:135] op_sel:[0,0] op_sel_hi:[1,0]
    v_pk_mul_f32 v[158:159], v[100:101], v[134:135] op_sel:[0,0] op_sel_hi:[1,0]
    v_pk_mul_f32 v[160:161], v[102:103], v[134:135] op_sel:[0,0] op_sel_hi:[1,0]
    v_pk_mul_f32 v[162:163], v[100:101], v[136:137] op_sel:[0,0] op_sel_hi:[1,0]
    v_pk_mul_f32 v[164:165], v[102:103], v[136:137] op_sel:[0,0] op_sel_hi:[1,0]
    v_pk_fma_f32 v[58:59], v[56:57], v[50:51], v[138:139] op_sel:[1,1,0] op_sel_hi:[0,1,1] neg_lo:[1,0,0]
    v_pk_fma_f32 v[60:61], v[56:57], v[52:53], v[140:141] op_sel:[1,1,0] op_sel_hi:[0,1,1] neg_lo:[1,0,0]
    v_pk_fma_f32 v[62:63], v[56:57], v[54:55], v[142:143] op_sel:[1,1,0] op_sel_hi:[0,1,1] neg_lo:[1,0,0]
    v_pk_fma_f32 v[70:71], v[64:65], v[54:55], v[144:145] op_sel:[1,1,0] op_sel_hi:[0,1,1] neg_lo:[1,0,0]
    v_pk_fma_f32 v[72:73], v[64:65], v[56:57], v[146:147] op_sel:[1,1,0] op_sel_hi:[0,1,1] neg_lo:[1,0,0]
    v_pk_fma_f32 v[90:91], v[88:89], v[82:83], v[148:149] op_sel:[1,1,0] op_sel_hi:[0,1,1] neg_lo:[1,0,0]
    v_pk_fma_f32 v[92:93], v[88:89], v[84:85], v[150:151] op_sel:[1,1,0] op_sel_hi:[0,1,1] neg_lo:[1,0,0]
    v_pk_fma_f32 v[94:95], v[88:89], v[86:87], v[152:153] op_sel:[1,1,0] op_sel_hi:[0,1,1] neg_lo:[1,0,0]
    v_pk_fma_f32 v[104:105], v[96:97], v[134:135], v[154:155] op_sel:[1,1,0] op_sel_hi:[0,1,1] neg_lo:[1,0,0]
    v_pk_fma_f32 v[106:107], v[98:99], v[134:135], v[156:157] op_sel:[1,1,0] op_sel_hi:[0,1,1] neg_lo:[1,0,0]
    v_pk_fma_f32 v[108:109], v[100:101], v[134:135], v[158:159] op_sel:[1,1,0] op_sel_hi:[0,1,1] neg_lo:[1,0,0]
    v_pk_fma_f32 v[110:111], v[102:103], v[134:135], v[160:161] op_sel:[1,1,0] op_sel_hi:[0,1,1] neg_lo:[1,0,0]
    v_pk_fma_f32 v[116:117], v[100:101], v[136:137], v[162:163] op_sel:[1,1,0] op_sel_hi:[0,1,1] neg_lo:[1,0,0]
    v_pk_fma_f32 v[118:119], v[102:103], v[136:137], v[164:165] op_sel:[1,1,0] op_sel_hi:[0,1,1] neg_lo:[1,0,0]
    v_pk_mul_f32 v[138:139], v[64:65], v[58:59] op_sel:[0,0] op_sel_hi:[1,0]
    v_pk_mul_f32 v[140:141], v[64:65], v[60:61] op_sel:[0,0] op_sel_hi:[1,0]
    v_pk_mul_f32 v[142:143], v[64:65], v[62:63] op_sel:[0,0] op_sel_hi:[1,0]
    v_pk_mul_f32 v[144:145], v[104:105], v[136:137] op_sel:[0,0] op_sel_hi:[1,0]
    v_pk_mul_f32 v[146:147], v[106:107], v[136:137] op_sel:[0,0] op_sel_hi:[1,0]
    v_pk_mul_f32 v[148:149], v[108:109], v[136:137] op_sel:[0,0] op_sel_hi:[1,0]
    v_pk_mul_f32 v[150:151], v[110:111], v[136:137] op_sel:[0,0] op_sel_hi:[1,0]
    v_pk_fma_f32 v[74:75], v[64:65], v[58:59], v[138:139] op_sel:[1,1,0] op_sel_hi:[0,1,1] neg_lo:[1,0,0]
    v_pk_fma_f32 v[76:77], v[64:65], v[60:61], v[140:141] op_sel:[1,1,0] op_sel_hi:[0,1,1] neg_lo:[1,0,0]
    v_pk_fma_f32 v[78:79], v[64:65], v[62:63], v[142:143] op_sel:[1,1,0] op_sel_hi:[0,1,1] neg_lo:[1,0,0]
    v_pk_fma_f32 v[120:121], v[104:105], v[136:137], v[144:145] op_sel:[1,1,0] op_sel_hi:[0,1,1] neg_lo:[1,0,0]
    v_pk_fma_f32 v[122:123], v[106:107], v[136:137], v[146:147] op_sel:[1,1,0] op_sel_hi:[0,1,1] neg_lo:[1,0,0]
    v_pk_fma_f32 v[124:125], v[108:109], v[136:137], v[148:149] op_sel:[1,1,0] op_sel_hi:[0,1,1] neg_lo:[1,0,0]
    v_pk_fma_f32 v[126:127], v[110:111], v[136:137], v[150:151] op_sel:[1,1,0] op_sel_hi:[0,1,1] neg_lo:[1,0,0]
    s_cmp_lg_u32 s83, 0
    s_cbranch_scc1 L_B_kslow
    v_pk_mul_f32 v[138:139], v[96:97], v[82:83] op_sel:[0,0] op_sel_hi:[1,0]
    v_pk_mul_f32 v[140:141], v[96:97], v[84:85] op_sel:[0,0] op_sel_hi:[1,0]
    v_pk_mul_f32 v[142:143], v[96:97], v[86:87] op_sel:[0,0] op_sel_hi:[1,0]
    v_pk_mul_f32 v[144:145], v[96:97], v[88:89] op_sel:[0,0] op_sel_hi:[1,0]
    v_pk_mul_f32 v[146:147], v[96:97], v[90:91] op_sel:[0,0] op_sel_hi:[1,0]
    v_pk_mul_f32 v[148:149], v[96:97], v[92:93] op_sel:[0,0] op_sel_hi:[1,0]
    v_pk_mul_f32 v[150:151], v[96:97], v[94:95] op_sel:[0,0] op_sel_hi:[1,0]
    v_pk_mul_f32 v[152:153], v[98:99], v[82:83] op_sel:[0,0] op_sel_hi:[1,0]
    v_pk_mul_f32 v[154:155], v[98:99], v[84:85] op_sel:[0,0] op_sel_hi:[1,0]
    v_pk_mul_f32 v[156:157], v[98:99], v[86:87] op_sel:[0,0] op_sel_hi:[1,0]
    v_pk_mul_f32 v[158:159], v[98:99], v[88:89] op_sel:[0,0] op_sel_hi:[1,0]
    v_pk_mul_f32 v[160:161], v[98:99], v[90:91] op_sel:[0,0] op_sel_hi:[1,0]
    v_pk_mul_f32 v[162:163], v[98:99], v[92:93] op_sel:[0,0] op_sel_hi:[1,0]
    v_pk_mul_f32 v[164:165], v[98:99], v[94:95] op_sel:[0,0] op_sel_hi:[1,0]
    v_pk_fma_f32 v[16:17], v[96:97], v[82:83], v[138:139] op_sel:[1,1,0] op_sel_hi:[0,1,1] neg_lo:[1,0,0]
    v_pk_fma_f32 v[18:19], v[96:97], v[84:85], v[140:141] op_sel:[1,1,0] op_sel_hi:[0,1,1] neg_lo:[1,0,0]
    v_pk_fma_f32 v[20:21], v[96:97], v[86:87], v[142:143] op_sel:[1,1,0] op_sel_hi:[0,1,1] neg_lo:[1,0,0]
    v_pk_fma_f32 v[22:23], v[96:97], v[88:89], v[144:145] op_sel:[1,1,0] op_sel_hi:[0,1,1] neg_lo:[1,0,0]
    v_pk_fma_f32 v[24:25], v[96:97], v[90:91], v[146:147] op_sel:[1,1,0] op_sel_hi:[0,1,1] neg_lo:[1,0,0]
    v_pk_fma_f32 v[26:27], v[96:97], v[92:93], v[148:149] op_sel:[1,1,0] op_sel_hi:[0,1,1] neg_lo:[1,0,0]
    v_pk_fma_f32 v[28:29], v[96:97], v[94:95], v[150:151] op_sel:[1,1,0] op_sel_hi:[0,1,1] neg_lo:[1,0,0]
    v_pk_fma_f32 v[30:31], v[98:99], v[82:83], v[152:153] op_sel:[1,1,0] op_sel_hi:[0,1,1] neg_lo:[1,0,0]
    v_pk_fma_f32 v[32:33], v[98:99], v[84:85], v[154:155] op_sel:[1,1,0] op_sel_hi:[0,1,1] neg_lo:[1,0,0]
    v_pk_fma_f32 v[34:35], v[98:99], v[86:87], v[156:157] op_sel:[1,1,0] op_sel_hi:[0,1,1] neg_lo:[1,0,0]
    v_pk_fma_f32 v[36:37], v[98:99], v[88:89], v[158:159] op_sel:[1,1,0] op_sel_hi:[0,1,1] neg_lo:[1,0,0]
    v_pk_fma_f32 v[38:39], v[98:99], v[90:91], v[160:161] op_sel:[1,1,0] op_sel_hi:[0,1,1] neg_lo:[1,0,0]
    v_pk_fma_f32 v[40:41], v[98:99], v[92:93], v[162:163] op_sel:[1,1,0] op_sel_hi:[0,1,1] neg_lo:[1,0,0]
    v_pk_fma_f32 v[42:43], v[98:99], v[94:95], v[164:165] op_sel:[1,1,0] op_sel_hi:[0,1,1] neg_lo:[1,0,0]
    v_cvt_pk_f16_f32 v170, v48, v49
    v_cvt_pk_f16_f32 v171, v96, v97
    v_cvt_pk_f16_f32 v172, v50, v51
    v_cvt_pk_f16_f32 v173, v16, v17
    ds_write2_b32 v216, v170, v171 offset0:0 offset1:64
    v_cvt_pk_f16_f32 v174, v52, v53
    v_cvt_pk_f16_f32 v175, v18, v19
    ds_write2_b32 v216, v172, v173 offset0:136 offset1:200
    v_cvt_pk_f16_f32 v176, v54, v55
    v_cvt_pk_f16_f32 v177, v20, v21
    ds_write2_b32 v217, v174, v175 offset0:0 offset1:64
    v_cvt_pk_f16_f32 v178, v56, v57
    v_cvt_pk_f16_f32 v179, v22, v23
    ds_write2_b32 v217, v176, v177 offset0:136 offset1:200
    v_cvt_pk_f16_f32 v180, v58, v59
    v_cvt_pk_f16_f32 v181, v24, v25
    ds_write2_b32 v218, v178, v179 offset0:0 offset1:64
    v_cvt_pk_f16_f32 v182, v60, v61
    v_cvt_pk_f16_f32 v183, v26, v27
    ds_write2_b32 v218, v180, v181 offset0:136 offset1:200
    v_cvt_pk_f16_f32 v184, v62, v63
    v_cvt_pk_f16_f32 v185, v28, v29
    ds_write2_b32 v219, v182, v183 offset0:0 offset1:64
    v_cvt_pk_f16_f32 v186, v64, v65
    v_cvt_pk_f16_f32 v187, v98, v99
    ds_write2_b32 v219, v184, v185 offset0:136 offset1:200
    v_cvt_pk_f16_f32 v188, v66, v67
    v_cvt_pk_f16_f32 v189, v30, v31
    ds_write2_b32 v220, v186, v187 offset0:0 offset1:64
    v_cvt_pk_f16_f32 v190, v68, v69
    v_cvt_pk_f16_f32 v191, v32, v33
    ds_write2_b32 v220, v188, v189 offset0:136 offset1:200
    v_cvt_pk_f16_f32 v192, v70, v71
    v_cvt_pk_f16_f32 v193, v34, v35
    ds_write2_b32 v221, v190, v191 offset0:0 offset1:64
    v_cvt_pk_f16_f32 v194, v72, v73
    v_cvt_pk_f16_f32 v195, v36, v37
    ds_write2_b32 v221, v192, v193 offset0:136 offset1:200
    v_cvt_pk_f16_f32 v196, v74, v75
    v_cvt_pk_f16_f32 v197, v38, v39
    ds_write2_b32 v222, v194, v195 offset0:0 offset1:64
    v_cvt_pk_f16_f32 v198, v76, v77
    v_cvt_pk_f16_f32 v199, v40, v41
    ds_write2_b32 v222, v196, v197 offset0:136 offset1:200
    v_cvt_pk_f16_f32 v200, v78, v79
    v_cvt_pk_f16_f32 v201, v42, v43
    ds_write2_b32 v223, v198, v199 offset0:0 offset1:64
    ds_write2_b32 v223, v200, v201 offset0:136 offset1:200
    ds_read_b128 v[48:51], v224 offset:0
    ds_read_b128 v[64:67], v224 offset:256
    ds_read_b128 v[52:55], v224 offset:64
    ds_read_b128 v[68:71], v224 offset:320
    ds_read_b128 v[56:59], v224 offset:128
    ds_read_b128 v[72:75], v224 offset:384
    ds_read_b128 v[60:63], v224 offset:192
    ds_read_b128 v[76:79], v224 offset:448
    v_pk_mul_f32 v[138:139], v[100:101], v[84:85] op_sel:[0,0] op_sel_hi:[1,0]
    v_pk_mul_f32 v[140:141], v[100:101], v[88:89] op_sel:[0,0] op_sel_hi:[1,0]
    v_pk_mul_f32 v[142:143], v[100:101], v[92:93] op_sel:[0,0] op_sel_hi:[1,0]
    v_pk_mul_f32 v[144:145], v[102:103], v[84:85] op_sel:[0,0] op_sel_hi:[1,0]
    v_pk_mul_f32 v[146:147], v[102:103], v[88:89] op_sel:[0,0] op_sel_hi:[1,0]
    v_pk_mul_f32 v[148:149], v[102:103], v[92:93] op_sel:[0,0] op_sel_hi:[1,0]
    v_pk_mul_f32 v[150:151], v[104:105], v[88:89] op_sel:[0,0] op_sel_hi:[1,0]
    v_pk_mul_f32 v[152:153], v[106:107], v[88:89] op_sel:[0,0] op_sel_hi:[1,0]
    v_pk_mul_f32 v[154:155], v[108:109], v[88:89] op_sel:[0,0] op_sel_hi:[1,0]
    v_pk_mul_f32 v[156:157], v[110:111], v[88:89] op_sel:[0,0] op_sel_hi:[1,0]
    v_pk_fma_f32 v[16:17], v[100:101], v[84:85], v[138:139] op_sel:[1,1,0] op_sel_hi:[0,1,1] neg_lo:[1,0,0]
    v_pk_fma_f32 v[18:19], v[100:101], v[88:89], v[140:141] op_sel:[1,1,0] op_sel_hi:[0,1,1] neg_lo:[1,0,0]
    v_pk_fma_f32 v[20:21], v[100:101], v[92:93], v[142:143] op_sel:[1,1,0] op_sel_hi:[0,1,1] neg_lo:[1,0,0]
    v_pk_fma_f32 v[22:23], v[102:103], v[84:85], v[144:145] op_sel:[1,1,0] op_sel_hi:[0,1,1] neg_lo:[1,0,0]
    v_pk_fma_f32 v[24:25], v[102:103], v[88:89], v[146:147] op_sel:[1,1,0] op_sel_hi:[0,1,1] neg_lo:[1,0,0]
    v_pk_fma_f32 v[26:27], v[102:103], v[92:93], v[148:149] op_sel:[1,1,0] op_sel_hi:[0,1,1] neg_lo:[1,0,0]
    v_pk_fma_f32 v[28:29], v[104:105], v[88:89], v[150:151] op_sel:[1,1,0] op_sel_hi:[0,1,1] neg_lo:[1,0,0]
    v_pk_fma_f32 v[30:31], v[106:107], v[88:89], v[152:153] op_sel:[1,1,0] op_sel_hi:[0,1,1] neg_lo:[1,0,0]
    v_pk_fma_f32 v[32:33], v[108:109], v[88:89], v[154:155] op_sel:[1,1,0] op_sel_hi:[0,1,1] neg_lo:[1,0,0]
    v_pk_fma_f32 v[34:35], v[110:111], v[88:89], v[156:157] op_sel:[1,1,0] op_sel_hi:[0,1,1] neg_lo:[1,0,0]
    v_cvt_pk_f16_f32 v170, v100, v101
    v_cvt_pk_f16_f32 v171, v112, v113
    v_cvt_pk_f16_f32 v172, v16, v17
    v_cvt_pk_f16_f32 v173, v114, v115
    ds_write2_b32 v216, v170, v171 offset0:0 offset1:64
    v_cvt_pk_f16_f32 v174, v18, v19
    v_cvt_pk_f16_f32 v175, v116, v117
    ds_write2_b32 v216, v172, v173 offset0:136 offset1:200
    v_cvt_pk_f16_f32 v176, v20, v21
    v_cvt_pk_f16_f32 v177, v118, v119
    ds_write2_b32 v217, v174, v175 offset0:0 offset1:64
    v_cvt_pk_f16_f32 v178, v102, v103
    v_cvt_pk_f16_f32 v179, v120, v121
    ds_write2_b32 v217, v176, v177 offset0:136 offset1:200
    v_cvt_pk_f16_f32 v180, v22, v23
    v_cvt_pk_f16_f32 v181, v122, v123
    ds_write2_b32 v218, v178, v179 offset0:0 offset1:64
    v_cvt_pk_f16_f32 v182, v24, v25
    v_cvt_pk_f16_f32 v183, v124, v125
    ds_write2_b32 v218, v180, v181 offset0:136 offset1:200
    v_cvt_pk_f16_f32 v184, v26, v27
    v_cvt_pk_f16_f32 v185, v126, v127
    ds_write2_b32 v219, v182, v183 offset0:0 offset1:64
    v_cvt_pk_f16_f32 v186, v104, v105
    v_cvt_pk_f16_f32 v187, v128, v129
    ds_write2_b32 v219, v184, v185 offset0:136 offset1:200
    v_cvt_pk_f16_f32 v188, v28, v29
    ds_write2_b32 v220, v186, v187 offset0:0 offset1:64
    v_cvt_pk_f16_f32 v190, v106, v107
    ds_write2_b32 v220, v188, v189 offset0:136 offset1:200
    v_cvt_pk_f16_f32 v192, v30, v31
    ds_write2_b32 v221, v190, v191 offset0:0 offset1:64
    v_cvt_pk_f16_f32 v194, v108, v109
    ds_write2_b32 v221, v192, v193 offset0:136 offset1:200
    v_cvt_pk_f16_f32 v196, v32, v33
    ds_write2_b32 v222, v194, v195 offset0:0 offset1:64
    v_cvt_pk_f16_f32 v198, v110, v111
    ds_write2_b32 v222, v196, v197 offset0:136 offset1:200
    v_cvt_pk_f16_f32 v200, v34, v35
    ds_write2_b32 v223, v198, v199 offset0:0 offset1:64
    ds_write2_b32 v223, v200, v201 offset0:136 offset1:200
    ds_read_b128 v[80:83], v224 offset:0
    ds_read_b128 v[96:99], v224 offset:256
    ds_read_b128 v[84:87], v224 offset:64
    ds_read_b128 v[100:103], v224 offset:320
    ds_read_b128 v[88:91], v224 offset:128
    ds_read_b128 v[104:107], v224 offset:384
    ds_read_b128 v[92:95], v224 offset:192
    ds_read_b128 v[108:111], v224 offset:448
    s_cmp_ge_u32 s4, 4
    s_cbranch_scc1 L_B_nou5f
    buffer_load_dwordx2 v[202:203], v3, s[8:11], 0 offen offset:0
    buffer_load_dwordx2 v[230:231], v3, s[8:11], 0 offen offset:1280
    buffer_load_dwordx2 v[252:253], v3, s[8:11], 0 offen offset:2560
    buffer_load_dwordx2 v[254:255], v3, s[8:11], 0 offen offset:3840
    buffer_load_dwordx2 v[188:189], v3, s[8:11], s93 offen offset:0
    buffer_load_dwordx2 v[190:191], v3, s[8:11], s93 offen offset:1280
    buffer_load_dwordx2 v[192:193], v3, s[8:11], s93 offen offset:2560
    buffer_load_dwordx2 v[194:195], v3, s[8:11], s93 offen offset:3840
    buffer_load_dword v229, s[20:23], s28 offen lds
    buffer_load_dword v229, s[20:23], s29 offen lds
L_B_nou5f:
    s_waitcnt lgkmcnt(15)
    v_mfma_f32_16x16x32_f16 v[204:207], v[64:67], v[48:51], 0
    v_mfma_f32_16x16x32_f16 v[204:207], v[68:71], v[52:55], v[204:207]
    v_mfma_f32_16x16x32_f16 v[204:207], v[72:75], v[56:59], v[204:207]
    v_mfma_f32_16x16x32_f16 v[204:207], v[76:79], v[60:63], v[204:207]
    s_waitcnt lgkmcnt(0)
    v_mfma_f32_16x16x32_f16 v[208:211], v[80:83], v[48:51], 0
    v_mfma_f32_16x16x32_f16 v[208:211], v[84:87], v[52:55], v[208:211]
    v_mfma_f32_16x16x32_f16 v[208:211], v[88:91], v[56:59], v[208:211]
    v_mfma_f32_16x16x32_f16 v[208:211], v[92:95], v[60:63], v[208:211]
    v_mfma_f32_16x16x32_f16 v[212:215], v[96:99], v[48:51], 0
    v_mfma_f32_16x16x32_f16 v[212:215], v[100:103], v[52:55], v[212:215]
    v_mfma_f32_16x16x32_f16 v[212:215], v[104:107], v[56:59], v[212:215]
    v_mfma_f32_16x16x32_f16 v[212:215], v[108:111], v[60:63], v[212:215]
    s_branch L_B_kdone
L_B_kslow:
    v_cvt_pk_bf16_f32 v170, v48, v49
    v_cvt_pk_bf16_f32 v172, v50, v51
    v_cvt_pk_bf16_f32 v174, v52, v53
    v_cvt_pk_bf16_f32 v176, v54, v55
    v_cvt_pk_bf16_f32 v178, v56, v57
    v_cvt_pk_bf16_f32 v180, v58, v59
    v_cvt_pk_bf16_f32 v182, v60, v61
    v_cvt_pk_bf16_f32 v184, v62, v63
    v_dot2_f32_bf16 v138, v170, s80, v48
    v_dot2_f32_bf16 v140, v172, s80, v50
    v_dot2_f32_bf16 v142, v174, s80, v52
    v_dot2_f32_bf16 v144, v176, s80, v54
    v_dot2_f32_bf16 v146, v178, s80, v56
    v_dot2_f32_bf16 v148, v180, s80, v58
    v_dot2_f32_bf16 v150, v182, s80, v60
    v_dot2_f32_bf16 v152, v184, s80, v62
    v_dot2_f32_bf16 v139, v170, s81, v49
    v_dot2_f32_bf16 v141, v172, s81, v51
    v_dot2_f32_bf16 v143, v174, s81, v53
    v_dot2_f32_bf16 v145, v176, s81, v55
    v_dot2_f32_bf16 v147, v178, s81, v57
    v_dot2_f32_bf16 v149, v180, s81, v59
    v_dot2_f32_bf16 v151, v182, s81, v61
    v_dot2_f32_bf16 v153, v184, s81, v63
    v_cvt_pk_bf16_f32 v171, v138, v139
    v_cvt_pk_bf16_f32 v173, v140, v141
    v_cvt_pk_bf16_f32 v175, v142, v143
    v_cvt_pk_bf16_f32 v177, v144, v145
    v_cvt_pk_bf16_f32 v179, v146, v147
    v_cvt_pk_bf16_f32 v181, v148, v149
    v_cvt_pk_bf16_f32 v183, v150, v151
    v_cvt_pk_bf16_f32 v185, v152, v153
    ds_write2_b32 v216, v170, v171 offset0:0 offset1:64
    ds_write2_b32 v216, v172, v173 offset0:136 offset1:200
    ds_write2_b32 v217, v174, v175 offset0:0 offset1:64
    ds_write2_b32 v217, v176, v177 offset0:136 offset1:200
    ds_write2_b32 v218, v178, v179 offset0:0 offset1:64
    ds_write2_b32 v218, v180, v181 offset0:136 offset1:200
    ds_write2_b32 v219, v182, v183 offset0:0 offset1:64
    ds_write2_b32 v219, v184, v185 offset0:136 offset1:200
    v_cvt_pk_bf16_f32 v186, v64, v65
    v_cvt_pk_bf16_f32 v188, v66, v67
    v_cvt_pk_bf16_f32 v190, v68, v69
    v_cvt_pk_bf16_f32 v192, v70, v71
    v_cvt_pk_bf16_f32 v194, v72, v73
    v_cvt_pk_bf16_f32 v196, v74, v75
    v_cvt_pk_bf16_f32 v198, v76, v77
    v_cvt_pk_bf16_f32 v200, v78, v79
    v_dot2_f32_bf16 v138, v186, s80, v64
    v_dot2_f32_bf16 v140, v188, s80, v66
    v_dot2_f32_bf16 v142, v190, s80, v68
    v_dot2_f32_bf16 v144, v192, s80, v70
    v_dot2_f32_bf16 v146, v194, s80, v72
    v_dot2_f32_bf16 v148, v196, s80, v74
    v_dot2_f32_bf16 v150, v198, s80, v76
    v_dot2_f32_bf16 v152, v200, s80, v78
    v_dot2_f32_bf16 v139, v186, s81, v65
    v_dot2_f32_bf16 v141, v188, s81, v67
    v_dot2_f32_bf16 v143, v190, s81, v69
    v_dot2_f32_bf16 v145, v192, s81, v71
    v_dot2_f32_bf16 v147, v194, s81, v73
    v_dot2_f32_bf16 v149, v196, s81, v75
    v_dot2_f32_bf16 v151, v198, s81, v77
    v_dot2_f32_bf16 v153, v200, s81, v79
    v_cvt_pk_bf16_f32 v187, v138, v139
    v_cvt_pk_bf16_f32 v189, v140, v141
    v_cvt_pk_bf16_f32 v191, v142, v143
    v_cvt_pk_bf16_f32 v193, v144, v145
    v_cvt_pk_bf16_f32 v195, v146, v147
    v_cvt_pk_bf16_f32 v197, v148, v149
    v_cvt_pk_bf16_f32 v199, v150, v151
    v_cvt_pk_bf16_f32 v201, v152, v153
    ds_write2_b32 v220, v186, v187 offset0:0 offset1:64
    ds_write2_b32 v220, v188, v189 offset0:136 offset1:200
    ds_write2_b32 v221, v190, v191 offset0:0 offset1:64
    ds_write2_b32 v221, v192, v193 offset0:136 offset1:200
    ds_write2_b32 v222, v194, v195 offset0:0 offset1:64
    ds_write2_b32 v222, v196, v197 offset0:136 offset1:200
    ds_write2_b32 v223, v198, v199 offset0:0 offset1:64
    ds_write2_b32 v223, v200, v201 offset0:136 offset1:200
    ds_read_b128 v[48:51], v224 offset:0
    ds_read_b128 v[64:67], v224 offset:256
    ds_read_b128 v[52:55], v224 offset:64
    ds_read_b128 v[68:71], v224 offset:320
    ds_read_b128 v[56:59], v224 offset:128
    ds_read_b128 v[72:75], v224 offset:384
    ds_read_b128 v[60:63], v224 offset:192
    ds_read_b128 v[76:79], v224 offset:448
    v_pk_mul_f32 v[138:139], v[96:97], v[82:83] op_sel:[0,0] op_sel_hi:[1,0]
    v_pk_mul_f32 v[140:141], v[96:97], v[84:85] op_sel:[0,0] op_sel_hi:[1,0]
    v_pk_mul_f32 v[142:143], v[96:97], v[86:87] op_sel:[0,0] op_sel_hi:[1,0]
    v_pk_mul_f32 v[144:145], v[96:97], v[88:89] op_sel:[0,0] op_sel_hi:[1,0]
    v_pk_mul_f32 v[146:147], v[96:97], v[90:91] op_sel:[0,0] op_sel_hi:[1,0]
    v_pk_mul_f32 v[148:149], v[96:97], v[92:93] op_sel:[0,0] op_sel_hi:[1,0]
    v_pk_mul_f32 v[150:151], v[96:97], v[94:95] op_sel:[0,0] op_sel_hi:[1,0]
    v_pk_mul_f32 v[152:153], v[98:99], v[82:83] op_sel:[0,0] op_sel_hi:[1,0]
    v_pk_mul_f32 v[154:155], v[98:99], v[84:85] op_sel:[0,0] op_sel_hi:[1,0]
    v_pk_mul_f32 v[156:157], v[98:99], v[86:87] op_sel:[0,0] op_sel_hi:[1,0]
    v_pk_mul_f32 v[158:159], v[98:99], v[88:89] op_sel:[0,0] op_sel_hi:[1,0]
    v_pk_mul_f32 v[160:161], v[98:99], v[90:91] op_sel:[0,0] op_sel_hi:[1,0]
    v_pk_mul_f32 v[162:163], v[98:99], v[92:93] op_sel:[0,0] op_sel_hi:[1,0]
    v_pk_mul_f32 v[164:165], v[98:99], v[94:95] op_sel:[0,0] op_sel_hi:[1,0]
    v_pk_fma_f32 v[16:17], v[96:97], v[82:83], v[138:139] op_sel:[1,1,0] op_sel_hi:[0,1,1] neg_lo:[1,0,0]
    v_pk_fma_f32 v[18:19], v[96:97], v[84:85], v[140:141] op_sel:[1,1,0] op_sel_hi:[0,1,1] neg_lo:[1,0,0]
    v_pk_fma_f32 v[20:21], v[96:97], v[86:87], v[142:143] op_sel:[1,1,0] op_sel_hi:[0,1,1] neg_lo:[1,0,0]
    v_pk_fma_f32 v[22:23], v[96:97], v[88:89], v[144:145] op_sel:[1,1,0] op_sel_hi:[0,1,1] neg_lo:[1,0,0]
    v_pk_fma_f32 v[24:25], v[96:97], v[90:91], v[146:147] op_sel:[1,1,0] op_sel_hi:[0,1,1] neg_lo:[1,0,0]
    v_pk_fma_f32 v[26:27], v[96:97], v[92:93], v[148:149] op_sel:[1,1,0] op_sel_hi:[0,1,1] neg_lo:[1,0,0]
    v_pk_fma_f32 v[28:29], v[96:97], v[94:95], v[150:151] op_sel:[1,1,0] op_sel_hi:[0,1,1] neg_lo:[1,0,0]
    v_pk_fma_f32 v[30:31], v[98:99], v[82:83], v[152:153] op_sel:[1,1,0] op_sel_hi:[0,1,1] neg_lo:[1,0,0]
    v_pk_fma_f32 v[32:33], v[98:99], v[84:85], v[154:155] op_sel:[1,1,0] op_sel_hi:[0,1,1] neg_lo:[1,0,0]
    v_pk_fma_f32 v[34:35], v[98:99], v[86:87], v[156:157] op_sel:[1,1,0] op_sel_hi:[0,1,1] neg_lo:[1,0,0]
    v_pk_fma_f32 v[36:37], v[98:99], v[88:89], v[158:159] op_sel:[1,1,0] op_sel_hi:[0,1,1] neg_lo:[1,0,0]
    v_pk_fma_f32 v[38:39], v[98:99], v[90:91], v[160:161] op_sel:[1,1,0] op_sel_hi:[0,1,1] neg_lo:[1,0,0]
    v_pk_fma_f32 v[40:41], v[98:99], v[92:93], v[162:163] op_sel:[1,1,0] op_sel_hi:[0,1,1] neg_lo:[1,0,0]
    v_pk_fma_f32 v[42:43], v[98:99], v[94:95], v[164:165] op_sel:[1,1,0] op_sel_hi:[0,1,1] neg_lo:[1,0,0]
    v_cvt_pk_bf16_f32 v170, v96, v97
    v_cvt_pk_bf16_f32 v172, v16, v17
    v_cvt_pk_bf16_f32 v174, v18, v19
    v_cvt_pk_bf16_f32 v176, v20, v21
    v_cvt_pk_bf16_f32 v178, v22, v23
    v_cvt_pk_bf16_f32 v180, v24, v25
    v_cvt_pk_bf16_f32 v182, v26, v27
    v_cvt_pk_bf16_f32 v184, v28, v29
    v_dot2_f32_bf16 v138, v170, s80, v96
    v_dot2_f32_bf16 v140, v172, s80, v16
    v_dot2_f32_bf16 v142, v174, s80, v18
    v_dot2_f32_bf16 v144, v176, s80, v20
    v_dot2_f32_bf16 v146, v178, s80, v22
    v_dot2_f32_bf16 v148, v180, s80, v24
    v_dot2_f32_bf16 v150, v182, s80, v26
    v_dot2_f32_bf16 v152, v184, s80, v28
    v_dot2_f32_bf16 v139, v170, s81, v97
    v_dot2_f32_bf16 v141, v172, s81, v17
    v_dot2_f32_bf16 v143, v174, s81, v19
    v_dot2_f32_bf16 v145, v176, s81, v21
    v_dot2_f32_bf16 v147, v178, s81, v23
    v_dot2_f32_bf16 v149, v180, s81, v25
    v_dot2_f32_bf16 v151, v182, s81, v27
    v_dot2_f32_bf16 v153, v184, s81, v29
    v_cvt_pk_bf16_f32 v171, v138, v139
    v_cvt_pk_bf16_f32 v173, v140, v141
    v_cvt_pk_bf16_f32 v175, v142, v143
    v_cvt_pk_bf16_f32 v177, v144, v145
    v_cvt_pk_bf16_f32 v179, v146, v147
    v_cvt_pk_bf16_f32 v181, v148, v149
    v_cvt_pk_bf16_f32 v183, v150, v151
    v_cvt_pk_bf16_f32 v185, v152, v153
    ds_write2_b32 v216, v170, v171 offset0:0 offset1:64
    ds_write2_b32 v216, v172, v173 offset0:136 offset1:200
    ds_write2_b32 v217, v174, v175 offset0:0 offset1:64
    ds_write2_b32 v217, v176, v177 offset0:136 offset1:200
    ds_write2_b32 v218, v178, v179 offset0:0 offset1:64
    ds_write2_b32 v218, v180, v181 offset0:136 offset1:200
    ds_write2_b32 v219, v182, v183 offset0:0 offset1:64
    ds_write2_b32 v219, v184, v185 offset0:136 offset1:200
    v_cvt_pk_bf16_f32 v186, v98, v99
    v_cvt_pk_bf16_f32 v188, v30, v31
    v_cvt_pk_bf16_f32 v190, v32, v33
    v_cvt_pk_bf16_f32 v192, v34, v35
    v_cvt_pk_bf16_f32 v194, v36, v37
    v_cvt_pk_bf16_f32 v196, v38, v39
    v_cvt_pk_bf16_f32 v198, v40, v41
    v_cvt_pk_bf16_f32 v200, v42, v43
    v_dot2_f32_bf16 v138, v186, s80, v98
    v_dot2_f32_bf16 v140, v188, s80, v30
    v_dot2_f32_bf16 v142, v190, s80, v32
    v_dot2_f32_bf16 v144, v192, s80, v34
    v_dot2_f32_bf16 v146, v194, s80, v36
    v_dot2_f32_bf16 v148, v196, s80, v38
    v_dot2_f32_bf16 v150, v198, s80, v40
    v_dot2_f32_bf16 v152, v200, s80, v42
    v_dot2_f32_bf16 v139, v186, s81, v99
    v_dot2_f32_bf16 v141, v188, s81, v31
    v_dot2_f32_bf16 v143, v190, s81, v33
    v_dot2_f32_bf16 v145, v192, s81, v35
    v_dot2_f32_bf16 v147, v194, s81, v37
    v_dot2_f32_bf16 v149, v196, s81, v39
    v_dot2_f32_bf16 v151, v198, s81, v41
    v_dot2_f32_bf16 v153, v200, s81, v43
    v_cvt_pk_bf16_f32 v187, v138, v139
    v_cvt_pk_bf16_f32 v189, v140, v141
    v_cvt_pk_bf16_f32 v191, v142, v143
    v_cvt_pk_bf16_f32 v193, v144, v145
    v_cvt_pk_bf16_f32 v195, v146, v147
    v_cvt_pk_bf16_f32 v197, v148, v149
    v_cvt_pk_bf16_f32 v199, v150, v151
    v_cvt_pk_bf16_f32 v201, v152, v153
    ds_write2_b32 v220, v186, v187 offset0:0 offset1:64
    ds_write2_b32 v220, v188, v189 offset0:136 offset1:200
    ds_write2_b32 v221, v190, v191 offset0:0 offset1:64
    ds_write2_b32 v221, v192, v193 offset0:136 offset1:200
    ds_write2_b32 v222, v194, v195 offset0:0 offset1:64
    ds_write2_b32 v222, v196, v197 offset0:136 offset1:200
    ds_write2_b32 v223, v198, v199 offset0:0 offset1:64
    ds_write2_b32 v223, v200, v201 offset0:136 offset1:200
    v_pk_mul_f32 v[138:139], v[100:101], v[84:85] op_sel:[0,0] op_sel_hi:[1,0]
    v_pk_mul_f32 v[140:141], v[100:101], v[88:89] op_sel:[0,0] op_sel_hi:[1,0]
    v_pk_mul_f32 v[142:143], v[100:101], v[92:93] op_sel:[0,0] op_sel_hi:[1,0]
    v_pk_mul_f32 v[144:145], v[102:103], v[84:85] op_sel:[0,0] op_sel_hi:[1,0]
    v_pk_mul_f32 v[146:147], v[102:103], v[88:89] op_sel:[0,0] op_sel_hi:[1,0]
    v_pk_mul_f32 v[148:149], v[102:103], v[92:93] op_sel:[0,0] op_sel_hi:[1,0]
    v_pk_mul_f32 v[150:151], v[104:105], v[88:89] op_sel:[0,0] op_sel_hi:[1,0]
    v_pk_mul_f32 v[152:153], v[106:107], v[88:89] op_sel:[0,0] op_sel_hi:[1,0]
    v_pk_mul_f32 v[154:155], v[108:109], v[88:89] op_sel:[0,0] op_sel_hi:[1,0]
    v_pk_mul_f32 v[156:157], v[110:111], v[88:89] op_sel:[0,0] op_sel_hi:[1,0]
    v_pk_fma_f32 v[16:17], v[100:101], v[84:85], v[138:139] op_sel:[1,1,0] op_sel_hi:[0,1,1] neg_lo:[1,0,0]
    v_pk_fma_f32 v[18:19], v[100:101], v[88:89], v[140:141] op_sel:[1,1,0] op_sel_hi:[0,1,1] neg_lo:[1,0,0]
    v_pk_fma_f32 v[20:21], v[100:101], v[92:93], v[142:143] op_sel:[1,1,0] op_sel_hi:[0,1,1] neg_lo:[1,0,0]
    v_pk_fma_f32 v[22:23], v[102:103], v[84:85], v[144:145] op_sel:[1,1,0] op_sel_hi:[0,1,1] neg_lo:[1,0,0]
    v_pk_fma_f32 v[24:25], v[102:103], v[88:89], v[146:147] op_sel:[1,1,0] op_sel_hi:[0,1,1] neg_lo:[1,0,0]
    v_pk_fma_f32 v[26:27], v[102:103], v[92:93], v[148:149] op_sel:[1,1,0] op_sel_hi:[0,1,1] neg_lo:[1,0,0]
    v_pk_fma_f32 v[28:29], v[104:105], v[88:89], v[150:151] op_sel:[1,1,0] op_sel_hi:[0,1,1] neg_lo:[1,0,0]
    v_pk_fma_f32 v[30:31], v[106:107], v[88:89], v[152:153] op_sel:[1,1,0] op_sel_hi:[0,1,1] neg_lo:[1,0,0]
    v_pk_fma_f32 v[32:33], v[108:109], v[88:89], v[154:155] op_sel:[1,1,0] op_sel_hi:[0,1,1] neg_lo:[1,0,0]
    v_pk_fma_f32 v[34:35], v[110:111], v[88:89], v[156:157] op_sel:[1,1,0] op_sel_hi:[0,1,1] neg_lo:[1,0,0]
    v_cvt_pk_bf16_f32 v170, v100, v101
    v_cvt_pk_bf16_f32 v172, v16, v17
    v_cvt_pk_bf16_f32 v174, v18, v19
    v_cvt_pk_bf16_f32 v176, v20, v21
    v_cvt_pk_bf16_f32 v178, v102, v103
    v_cvt_pk_bf16_f32 v180, v22, v23
    v_cvt_pk_bf16_f32 v182, v24, v25
    v_cvt_pk_bf16_f32 v184, v26, v27
    v_dot2_f32_bf16 v138, v170, s80, v100
    v_dot2_f32_bf16 v140, v172, s80, v16
    v_dot2_f32_bf16 v142, v174, s80, v18
    v_dot2_f32_bf16 v144, v176, s80, v20
    v_dot2_f32_bf16 v146, v178, s80, v102
    v_dot2_f32_bf16 v148, v180, s80, v22
    v_dot2_f32_bf16 v150, v182, s80, v24
    v_dot2_f32_bf16 v152, v184, s80, v26
    v_dot2_f32_bf16 v139, v170, s81, v101
    v_dot2_f32_bf16 v141, v172, s81, v17
    v_dot2_f32_bf16 v143, v174, s81, v19
    v_dot2_f32_bf16 v145, v176, s81, v21
    v_dot2_f32_bf16 v147, v178, s81, v103
    v_dot2_f32_bf16 v149, v180, s81, v23
    v_dot2_f32_bf16 v151, v182, s81, v25
    v_dot2_f32_bf16 v153, v184, s81, v27
    v_cvt_pk_bf16_f32 v171, v138, v139
    v_cvt_pk_bf16_f32 v173, v140, v141
    v_cvt_pk_bf16_f32 v175, v142, v143
    v_cvt_pk_bf16_f32 v177, v144, v145
    v_cvt_pk_bf16_f32 v179, v146, v147
    v_cvt_pk_bf16_f32 v181, v148, v149
    v_cvt_pk_bf16_f32 v183, v150, v151
    v_cvt_pk_bf16_f32 v185, v152, v153
    v_cvt_pk_bf16_f32 v186, v104, v105
    v_cvt_pk_bf16_f32 v188, v28, v29
    v_cvt_pk_bf16_f32 v190, v106, v107
    v_cvt_pk_bf16_f32 v192, v30, v31
    v_cvt_pk_bf16_f32 v194, v108, v109
    v_cvt_pk_bf16_f32 v196, v32, v33
    v_cvt_pk_bf16_f32 v198, v110, v111
    v_cvt_pk_bf16_f32 v200, v34, v35
    v_dot2_f32_bf16 v138, v186, s80, v104
    v_dot2_f32_bf16 v140, v188, s80, v28
    v_dot2_f32_bf16 v142, v190, s80, v106
    v_dot2_f32_bf16 v144, v192, s80, v30
    v_dot2_f32_bf16 v146, v194, s80, v108
    v_dot2_f32_bf16 v148, v196, s80, v32
    v_dot2_f32_bf16 v150, v198, s80, v110
    v_dot2_f32_bf16 v152, v200, s80, v34
    v_dot2_f32_bf16 v139, v186, s81, v105
    v_dot2_f32_bf16 v141, v188, s81, v29
    v_dot2_f32_bf16 v143, v190, s81, v107
    v_dot2_f32_bf16 v145, v192, s81, v31
    v_dot2_f32_bf16 v147, v194, s81, v109
    v_dot2_f32_bf16 v149, v196, s81, v33
    v_dot2_f32_bf16 v151, v198, s81, v111
    v_dot2_f32_bf16 v153, v200, s81, v35
    v_cvt_pk_bf16_f32 v187, v138, v139
    v_cvt_pk_bf16_f32 v189, v140, v141
    v_cvt_pk_bf16_f32 v191, v142, v143
    v_cvt_pk_bf16_f32 v193, v144, v145
    v_cvt_pk_bf16_f32 v195, v146, v147
    v_cvt_pk_bf16_f32 v197, v148, v149
    v_cvt_pk_bf16_f32 v199, v150, v151
    v_cvt_pk_bf16_f32 v201, v152, v153
    ds_read_b128 v[80:83], v224 offset:0
    ds_read_b128 v[96:99], v224 offset:256
    ds_read_b128 v[84:87], v224 offset:64
    ds_read_b128 v[100:103], v224 offset:320
    ds_read_b128 v[88:91], v224 offset:128
    ds_read_b128 v[104:107], v224 offset:384
    ds_read_b128 v[92:95], v224 offset:192
    ds_read_b128 v[108:111], v224 offset:448
    ds_write2_b32 v216, v170, v171 offset0:0 offset1:64
    ds_write2_b32 v216, v172, v173 offset0:136 offset1:200
    ds_write2_b32 v217, v174, v175 offset0:0 offset1:64
    ds_write2_b32 v217, v176, v177 offset0:136 offset1:200
    ds_write2_b32 v218, v178, v179 offset0:0 offset1:64
    ds_write2_b32 v218, v180, v181 offset0:136 offset1:200
    ds_write2_b32 v219, v182, v183 offset0:0 offset1:64
    ds_write2_b32 v219, v184, v185 offset0:136 offset1:200
    ds_write2_b32 v220, v186, v187 offset0:0 offset1:64
    ds_write2_b32 v220, v188, v189 offset0:136 offset1:200
    ds_write2_b32 v221, v190, v191 offset0:0 offset1:64
    ds_write2_b32 v221, v192, v193 offset0:136 offset1:200
    ds_write2_b32 v222, v194, v195 offset0:0 offset1:64
    ds_write2_b32 v222, v196, v197 offset0:136 offset1:200
    ds_write2_b32 v223, v198, v199 offset0:0 offset1:64
    ds_write2_b32 v223, v200, v201 offset0:136 offset1:200
    ds_read_b128 v[16:19], v224 offset:0
    ds_read_b128 v[32:35], v224 offset:256
    ds_read_b128 v[20:23], v224 offset:64
    ds_read_b128 v[36:39], v224 offset:320
    ds_read_b128 v[24:27], v224 offset:128
    ds_read_b128 v[40:43], v224 offset:384
    ds_read_b128 v[28:31], v224 offset:192
    ds_read_b128 v[44:47], v224 offset:448
    v_cvt_pk_bf16_f32 v170, v112, v113
    v_cvt_pk_bf16_f32 v172, v114, v115
    v_cvt_pk_bf16_f32 v174, v116, v117
    v_cvt_pk_bf16_f32 v176, v118, v119
    v_cvt_pk_bf16_f32 v178, v120, v121
    v_dot2_f32_bf16 v138, v170, s80, v112
    v_dot2_f32_bf16 v140, v172, s80, v114
    v_dot2_f32_bf16 v142, v174, s80, v116
    v_dot2_f32_bf16 v144, v176, s80, v118
    v_dot2_f32_bf16 v146, v178, s80, v120
    v_dot2_f32_bf16 v139, v170, s81, v113
    v_dot2_f32_bf16 v141, v172, s81, v115
    v_dot2_f32_bf16 v143, v174, s81, v117
    v_dot2_f32_bf16 v145, v176, s81, v119
    v_dot2_f32_bf16 v147, v178, s81, v121
    v_cvt_pk_bf16_f32 v171, v138, v139
    v_cvt_pk_bf16_f32 v173, v140, v141
    v_cvt_pk_bf16_f32 v175, v142, v143
    v_cvt_pk_bf16_f32 v177, v144, v145
    v_cvt_pk_bf16_f32 v179, v146, v147
    ds_write2_b32 v216, v170, v171 offset0:0 offset1:64
    ds_write2_b32 v216, v172, v173 offset0:136 offset1:200
    ds_write2_b32 v217, v174, v175 offset0:0 offset1:64
    ds_write2_b32 v217, v176, v177 offset0:136 offset1:200
    ds_write2_b32 v218, v178, v179 offset0:0 offset1:64
    v_cvt_pk_bf16_f32 v180, v122, v123
    v_cvt_pk_bf16_f32 v182, v124, v125
    v_cvt_pk_bf16_f32 v184, v126, v127
    v_cvt_pk_bf16_f32 v186, v128, v129
    v_dot2_f32_bf16 v138, v180, s80, v122
    v_dot2_f32_bf16 v140, v182, s80, v124
    v_dot2_f32_bf16 v142, v184, s80, v126
    v_dot2_f32_bf16 v144, v186, s80, v128
    v_dot2_f32_bf16 v139, v180, s81, v123
    v_dot2_f32_bf16 v141, v182, s81, v125
    v_dot2_f32_bf16 v143, v184, s81, v127
    v_dot2_f32_bf16 v145, v186, s81, v129
    v_cvt_pk_bf16_f32 v181, v138, v139
    v_cvt_pk_bf16_f32 v183, v140, v141
    v_cvt_pk_bf16_f32 v185, v142, v143
    v_cvt_pk_bf16_f32 v187, v144, v145
    ds_write2_b32 v218, v180, v181 offset0:136 offset1:200
    ds_write2_b32 v219, v182, v183 offset0:0 offset1:64
    ds_write2_b32 v219, v184, v185 offset0:136 offset1:200
    ds_write2_b32 v220, v186, v187 offset0:0 offset1:64
    s_cmp_ge_u32 s4, 4
    s_cbranch_scc1 L_B_nou5s
    buffer_load_dwordx2 v[202:203], v3, s[8:11], 0 offen offset:0
    buffer_load_dwordx2 v[230:231], v3, s[8:11], 0 offen offset:1280
    buffer_load_dwordx2 v[252:253], v3, s[8:11], 0 offen offset:2560
    buffer_load_dwordx2 v[254:255], v3, s[8:11], 0 offen offset:3840
    buffer_load_dwordx2 v[188:189], v3, s[8:11], s93 offen offset:0
    buffer_load_dwordx2 v[190:191], v3, s[8:11], s93 offen offset:1280
    buffer_load_dwordx2 v[192:193], v3, s[8:11], s93 offen offset:2560
    buffer_load_dwordx2 v[194:195], v3, s[8:11], s93 offen offset:3840
    buffer_load_dword v229, s[20:23], s28 offen lds
    buffer_load_dword v229, s[20:23], s29 offen lds
L_B_nou5s:
    s_waitcnt lgkmcnt(15)
    v_mfma_f32_16x16x32_bf16 v[204:207], v[96:99], v[48:51], 0
    v_mfma_f32_16x16x32_bf16 v[204:207], v[80:83], v[64:67], v[204:207]
    v_mfma_f32_16x16x32_bf16 v[204:207], v[80:83], v[48:51], v[204:207]
    v_mfma_f32_16x16x32_bf16 v[204:207], v[100:103], v[52:55], v[204:207]
    v_mfma_f32_16x16x32_bf16 v[204:207], v[84:87], v[68:71], v[204:207]
    v_mfma_f32_16x16x32_bf16 v[204:207], v[84:87], v[52:55], v[204:207]
    v_mfma_f32_16x16x32_bf16 v[204:207], v[104:107], v[56:59], v[204:207]
    v_mfma_f32_16x16x32_bf16 v[204:207], v[88:91], v[72:75], v[204:207]
    v_mfma_f32_16x16x32_bf16 v[204:207], v[88:91], v[56:59], v[204:207]
    v_mfma_f32_16x16x32_bf16 v[204:207], v[108:111], v[60:63], v[204:207]
    v_mfma_f32_16x16x32_bf16 v[204:207], v[92:95], v[76:79], v[204:207]
    v_mfma_f32_16x16x32_bf16 v[204:207], v[92:95], v[60:63], v[204:207]
    s_waitcnt lgkmcnt(9)
    v_mfma_f32_16x16x32_bf16 v[208:211], v[32:35], v[48:51], 0
    v_mfma_f32_16x16x32_bf16 v[208:211], v[16:19], v[64:67], v[208:211]
    v_mfma_f32_16x16x32_bf16 v[208:211], v[16:19], v[48:51], v[208:211]
    v_mfma_f32_16x16x32_bf16 v[208:211], v[36:39], v[52:55], v[208:211]
    v_mfma_f32_16x16x32_bf16 v[208:211], v[20:23], v[68:71], v[208:211]
    v_mfma_f32_16x16x32_bf16 v[208:211], v[20:23], v[52:55], v[208:211]
    v_mfma_f32_16x16x32_bf16 v[208:211], v[40:43], v[56:59], v[208:211]
    v_mfma_f32_16x16x32_bf16 v[208:211], v[24:27], v[72:75], v[208:211]
    v_mfma_f32_16x16x32_bf16 v[208:211], v[24:27], v[56:59], v[208:211]
    v_mfma_f32_16x16x32_bf16 v[208:211], v[44:47], v[60:63], v[208:211]
    v_mfma_f32_16x16x32_bf16 v[208:211], v[28:31], v[76:79], v[208:211]
    v_mfma_f32_16x16x32_bf16 v[208:211], v[28:31], v[60:63], v[208:211]
    ds_read_b128 v[80:83], v224 offset:0
    ds_read_b128 v[96:99], v224 offset:256
    ds_read_b128 v[84:87], v224 offset:64
    ds_read_b128 v[100:103], v224 offset:320
    ds_read_b128 v[88:91], v224 offset:128
    ds_read_b128 v[104:107], v224 offset:384
    ds_read_b128 v[92:95], v224 offset:192
    ds_read_b128 v[108:111], v224 offset:448
    s_waitcnt lgkmcnt(0)
    v_mfma_f32_16x16x32_bf16 v[212:215], v[96:99], v[48:51], 0
    v_mfma_f32_16x16x32_bf16 v[212:215], v[80:83], v[64:67], v[212:215]
    v_mfma_f32_16x16x32_bf16 v[212:215], v[80:83], v[48:51], v[212:215]
    v_mfma_f32_16x16x32_bf16 v[212:215], v[100:103], v[52:55], v[212:215]
    v_mfma_f32_16x16x32_bf16 v[212:215], v[84:87], v[68:71], v[212:215]
    v_mfma_f32_16x16x32_bf16 v[212:215], v[84:87], v[52:55], v[212:215]
    v_mfma_f32_16x16x32_bf16 v[212:215], v[104:107], v[56:59], v[212:215]
    v_mfma_f32_16x16x32_bf16 v[212:215], v[88:91], v[72:75], v[212:215]
    v_mfma_f32_16x16x32_bf16 v[212:215], v[88:91], v[56:59], v[212:215]
    v_mfma_f32_16x16x32_bf16 v[212:215], v[108:111], v[60:63], v[212:215]
    v_mfma_f32_16x16x32_bf16 v[212:215], v[92:95], v[76:79], v[212:215]
    v_mfma_f32_16x16x32_bf16 v[212:215], v[92:95], v[60:63], v[212:215]
L_B_kdone:
    s_nop 7
    v_mul_f32 v204, s77, v204
    v_mul_f32 v205, s77, v205
    v_mul_f32 v206, s77, v206
    v_mul_f32 v207, s77, v207
    v_mul_f32 v208, s77, v208
    v_mul_f32 v209, s77, v209
    v_mul_f32 v210, s77, v210
    v_mul_f32 v211, s77, v211
    v_mul_f32 v212, s77, v212
    v_mul_f32 v213, s77, v213
    v_mul_f32 v214, s77, v214
    v_mul_f32 v215, s77, v215
    ds_write_b32 v225, v204 offset:0
    ds_write_b32 v225, v205 offset:4
    ds_write_b32 v225, v206 offset:8
    ds_write_b32 v225, v207 offset:12
    ds_write_b32 v226, v208
    ds_write_b32 v226, v209 offset:4
    ds_write_b32 v227, v210
    ds_write_b32 v227, v211 offset:4
    ds_write_b32 v228, v212 offset:0
    ds_write_b32 v228, v213 offset:72
    ds_write_b32 v228, v214 offset:144
    ds_write_b32 v228, v215 offset:216
    ds_add_u32 v2, v14 offset:64
    ds_read_b32 v15, v2 offset:64
    s_waitcnt lgkmcnt(0)
    v_readfirstlane_b32 s5, v15
    s_cmp_lt_u32 s5, 2
    s_cbranch_scc1 L_spin_38
L_ok_37:
    s_cmp_lg_u32 s65, 0
    s_cbranch_scc1 L_B_g1
    ds_read2st64_b32 v[48:49], v232 offset0:0 offset1:34
    ds_read2st64_b32 v[50:51], v233 offset0:0 offset1:34
    ds_read2st64_b32 v[52:53], v234 offset0:0 offset1:34
    ds_read2st64_b32 v[54:55], v235 offset0:0 offset1:34
    ds_read2st64_b32 v[56:57], v236 offset0:0 offset1:34
    ds_read2st64_b32 v[58:59], v237 offset0:0 offset1:34
    ds_read2st64_b32 v[60:61], v238 offset0:0 offset1:34
    ds_read2st64_b32 v[62:63], v239 offset0:0 offset1:34
    ds_read2st64_b32 v[64:65], v240 offset0:0 offset1:34
    ds_read2st64_b32 v[66:67], v241 offset0:0 offset1:34
    ds_read2st64_b32 v[68:69], v242 offset0:0 offset1:34
    ds_read2st64_b32 v[70:71], v243 offset0:0 offset1:34
    ds_read2st64_b32 v[72:73], v244 offset0:0 offset1:34
    ds_read2st64_b32 v[74:75], v245 offset0:0 offset1:34
    v_and_b32 v92, 15, v1
    v_lshrrev_b32 v93, 4, v1
    v_lshlrev_b32 v93, 3, v93
    v_add_u32 v92, v92, v93
    v_sub_u32 v92, 15, v92
    v_and_b32 v93, 1, v92
    v_lshlrev_b32 v93, 4, v93
    v_lshlrev_b32_e64 v93, v93, s92
    v_ashrrev_i32 v92, 1, v92
    v_cmp_eq_u32 vcc, 0, v92
    s_nop 1
    v_cndmask_b32 v44, 0, v93, vcc
    v_cmp_eq_u32 vcc, 1, v92
    s_nop 1
    v_cndmask_b32 v45, 0, v93, vcc
    v_cmp_eq_u32 vcc, 2, v92
    s_nop 1
    v_cndmask_b32 v46, 0, v93, vcc
    v_cmp_eq_u32 vcc, 3, v92
    s_nop 1
    v_cndmask_b32 v47, 0, v93, vcc
    s_waitcnt lgkmcnt(3)
    v_add_f32 v48, v48, v49
    v_add_f32 v50, v50, v51
    v_add_f32 v52, v52, v53
    v_add_f32 v54, v54, v55
    v_add_f32 v56, v56, v57
    v_add_f32 v58, v58, v59
    v_add_f32 v60, v60, v61
    v_add_f32 v62, v62, v63
    v_add_f32 v64, v64, v65
    v_add_f32 v66, v66, v67
    v_add_f32 v68, v68, v69
    v_cvt_pk_bf16_f32 v96, v48, v50
    v_cvt_pk_bf16_f32 v97, v52, v54
    v_cvt_pk_bf16_f32 v98, v56, v58
    v_cvt_pk_bf16_f32 v99, v60, v62
    v_cvt_pk_bf16_f32 v100, v50, v52
    v_cvt_pk_bf16_f32 v101, v54, v56
    v_cvt_pk_bf16_f32 v102, v58, v60
    v_cvt_pk_bf16_f32 v103, v62, v64
    v_cvt_pk_bf16_f32 v104, v52, v54
    v_cvt_pk_bf16_f32 v105, v56, v58
    v_cvt_pk_bf16_f32 v106, v60, v62
    v_cvt_pk_bf16_f32 v107, v64, v66
    v_cvt_pk_bf16_f32 v108, v54, v56
    v_cvt_pk_bf16_f32 v109, v58, v60
    v_cvt_pk_bf16_f32 v110, v62, v64
    v_cvt_pk_bf16_f32 v111, v66, v68
    ds_write_b128 v250, v[96:99] offset:32
    ds_write_b128 v250, v[100:103] offset:4192
    ds_write_b128 v250, v[104:107] offset:8352
    ds_write_b128 v250, v[108:111] offset:12512
    s_waitcnt lgkmcnt(4)
    v_add_f32 v70, v70, v71
    v_add_f32 v72, v72, v73
    v_add_f32 v74, v74, v75
    v_cvt_pk_bf16_f32 v112, v70, v70
    v_cvt_pk_bf16_f32 v113, v70, v72
    v_cvt_pk_bf16_f32 v114, v72, v72
    v_cvt_pk_bf16_f32 v115, v74, v74
    v_cvt_pk_bf16_f32 v116, v70, v70
    v_cvt_pk_bf16_f32 v117, v72, v72
    v_cvt_pk_bf16_f32 v118, v72, v74
    v_cvt_pk_bf16_f32 v119, v74, v74
    v_cvt_pk_bf16_f32 v120, v70, v72
    v_cvt_pk_bf16_f32 v121, v72, v72
    v_cvt_pk_bf16_f32 v122, v74, v74
    v_cvt_pk_bf16_f32 v123, v74, v74
    v_cvt_pk_bf16_f32 v124, v72, v72
    v_cvt_pk_bf16_f32 v125, v72, v74
    v_cvt_pk_bf16_f32 v126, v74, v74
    v_cvt_pk_bf16_f32 v127, v74, v74
    ds_write_b128 v250, v[112:115] offset:1056
    ds_write_b128 v250, v[116:119] offset:5216
    ds_write_b128 v250, v[120:123] offset:9376
    ds_write_b128 v250, v[124:127] offset:13536
    v_lshlrev_b32 v32, 2, v1
    v_add_u32 v32, s84, v32
    v_readlane_b32 s30, v96, 0
    v_readlane_b32 s31, v100, 0
    v_mov_b32 v34, 0
    v_mov_b32 v35, 0
    v_mov_b32 v36, 0
    v_mov_b32 v37, 0
    s_lshl_b32 s5, s30, 16
    v_writelane_b32 v35, s5, 7
    v_writelane_b32 v36, s30, 7
    v_writelane_b32 v37, s5, 6
    v_writelane_b32 v37, s31, 7
    s_mov_b64 exec, 0xff
    ds_write_b32 v32, v34 offset:0
    ds_write_b32 v32, v35 offset:4160
    ds_write_b32 v32, v36 offset:8320
    ds_write_b32 v32, v37 offset:12480
    s_mov_b64 exec, -1
    s_branch L_B_nopad
L_B_g1:
    ds_read2st64_b32 v[48:49], v232 offset0:0 offset1:34
    ds_read2st64_b32 v[50:51], v233 offset0:0 offset1:34
    ds_read2st64_b32 v[52:53], v234 offset0:0 offset1:34
    ds_read2st64_b32 v[54:55], v235 offset0:0 offset1:34
    ds_read2st64_b32 v[56:57], v236 offset0:0 offset1:34
    ds_read2st64_b32 v[58:59], v237 offset0:0 offset1:34
    v_and_b32 v92, 15, v1
    v_lshrrev_b32 v93, 4, v1
    v_lshlrev_b32 v93, 3, v93
    v_add_u32 v92, v92, v93
    v_sub_u32 v92, 15, v92
    v_and_b32 v93, 1, v92
    v_lshlrev_b32 v93, 4, v93
    v_lshlrev_b32_e64 v93, v93, s92
    v_ashrrev_i32 v92, 1, v92
    v_cmp_eq_u32 vcc, 0, v92
    s_nop 1
    v_cndmask_b32 v44, 0, v93, vcc
    v_cmp_eq_u32 vcc, 1, v92
    s_nop 1
    v_cndmask_b32 v45, 0, v93, vcc
    v_cmp_eq_u32 vcc, 2, v92
    s_nop 1
    v_cndmask_b32 v46, 0, v93, vcc
    v_cmp_eq_u32 vcc, 3, v92
    s_nop 1
    v_cndmask_b32 v47, 0, v93, vcc
    s_waitcnt lgkmcnt(3)
    v_add_f32 v48, v48, v49
    v_add_f32 v50, v50, v51
    v_add_f32 v52, v52, v53
    v_cvt_pk_bf16_f32 v96, v48, v48
    v_cvt_pk_bf16_f32 v97, v48, v48
    v_cvt_pk_bf16_f32 v98, v52, v50
    v_cvt_pk_bf16_f32 v99, v50, v50
    v_cvt_pk_bf16_f32 v100, v48, v48
    v_cvt_pk_bf16_f32 v101, v48, v52
    v_cvt_pk_bf16_f32 v102, v50, v50
    v_cvt_pk_bf16_f32 v103, v50, v50
    v_cvt_pk_bf16_f32 v104, v48, v48
    v_cvt_pk_bf16_f32 v105, v52, v50
    v_cvt_pk_bf16_f32 v106, v50, v50
    v_cvt_pk_bf16_f32 v107, v50, v50
    v_cvt_pk_bf16_f32 v108, v48, v52
    v_cvt_pk_bf16_f32 v109, v50, v50
    v_cvt_pk_bf16_f32 v110, v50, v50
    v_cvt_pk_bf16_f32 v111, v50, v50
    ds_write_b128 v250, v[96:99] offset:32
    ds_write_b128 v250, v[100:103] offset:4192
    ds_write_b128 v250, v[104:107] offset:8352
    ds_write_b128 v250, v[108:111] offset:12512
    s_waitcnt lgkmcnt(4)
    v_add_f32 v54, v54, v55
    v_add_f32 v56, v56, v57
    v_add_f32 v58, v58, v59
    v_cvt_pk_bf16_f32 v112, v54, v54
    v_cvt_pk_bf16_f32 v113, v54, v54
    v_cvt_pk_bf16_f32 v114, v58, v56
    v_cvt_pk_bf16_f32 v115, v56, v56
    v_cvt_pk_bf16_f32 v116, v54, v54
    v_cvt_pk_bf16_f32 v117, v54, v58
    v_cvt_pk_bf16_f32 v118, v56, v56
    v_cvt_pk_bf16_f32 v119, v56, v56
    v_cvt_pk_bf16_f32 v120, v54, v54
    v_cvt_pk_bf16_f32 v121, v58, v56
    v_cvt_pk_bf16_f32 v122, v56, v56
    v_cvt_pk_bf16_f32 v123, v56, v56
    v_cvt_pk_bf16_f32 v124, v54, v58
    v_cvt_pk_bf16_f32 v125, v56, v56
    v_cvt_pk_bf16_f32 v126, v56, v56
    v_cvt_pk_bf16_f32 v127, v56, v56
    ds_write_b128 v250, v[112:115] offset:1056
    ds_write_b128 v250, v[116:119] offset:5216
    ds_write_b128 v250, v[120:123] offset:9376
    ds_write_b128 v250, v[124:127] offset:13536
L_B_nopad:
    ds_add_u32 v2, v14 offset:80
    s_cmp_ge_u32 s4, 4
    s_cbranch_scc1 L_B_nou6
    s_mov_b32 s78, 0x05040100
    s_mov_b32 s79, 0x07060302
    s_waitcnt vmcnt(6)
    v_perm_b32 v138, v252, v254, s78
    v_perm_b32 v139, v202, v230, s78
    ds_write_b64 v4, v[138:139] offset:2048
    v_perm_b32 v140, v252, v254, s79
    v_perm_b32 v141, v202, v230, s79
    ds_write_b64 v4, v[140:141] offset:6656
    v_perm_b32 v142, v253, v255, s78
    v_perm_b32 v143, v203, v231, s78
    ds_write_b64 v4, v[142:143] offset:11264
    v_perm_b32 v144, v253, v255, s79
    v_perm_b32 v145, v203, v231, s79
    ds_write_b64 v4, v[144:145] offset:15872
    ds_write_b32 v5, v14 offset:0
    s_waitcnt vmcnt(2)
    v_perm_b32 v146, v192, v194, s78
    v_perm_b32 v147, v188, v190, s78
    ds_write_b64 v4, v[146:147] offset:0
    v_perm_b32 v148, v192, v194, s79
    v_perm_b32 v149, v188, v190, s79
    ds_write_b64 v4, v[148:149] offset:4608
    v_perm_b32 v150, v193, v195, s78
    v_perm_b32 v151, v189, v191, s78
    ds_write_b64 v4, v[150:151] offset:9216
    v_perm_b32 v152, v193, v195, s79
    v_perm_b32 v153, v189, v191, s79
    ds_write_b64 v4, v[152:153] offset:13824
    ds_write_b32 v5, v14 offset:16
L_B_nou6:
    v_mov_b32 v7, v5
    v_lshlrev_b32 v5, 4, v1
    v_add_u32 v5, s86, v5
    v_and_b32 v6, 3, v1
    v_lshrrev_b32 v32, 2, v1
    v_lshl_add_u32 v6, v6, 4, v32
    v_lshlrev_b32 v6, 4, v6
    s_lshl_b32 s5, s4, 10
    s_add_u32 s5, s5, 85632
    v_add_u32 v6, s5, v6
    s_waitcnt lgkmcnt(0)
    ds_read_b32 v15, v2 offset:80
    s_waitcnt lgkmcnt(0)
    v_readfirstlane_b32 s5, v15
    s_cmp_lt_u32 s5, 2
    s_cbranch_scc1 L_spin_40
L_ok_39:
    s_cmp_lg_u32 s65, 0
    s_cbranch_scc1 L_B_h1
    s_bitcmp1_b32 s97, 0
    s_cbranch_scc0 L_spin_42
L_ok_41:
    ds_read_b64 v[96:97], v8 offset:0
    ds_read_b64 v[98:99], v8 offset:8
    ds_read_b128 v[48:51], v12 offset:3584
    ds_read_b64 v[100:101], v8 offset:64
    ds_read_b64 v[102:103], v8 offset:72
    ds_read_b128 v[52:55], v12 offset:3648
    ds_read_b64 v[104:105], v8 offset:128
    ds_read_b64 v[106:107], v8 offset:136
    ds_read_b128 v[56:59], v12 offset:3712
    ds_read_b64 v[108:109], v8 offset:192
    ds_read_b64 v[110:111], v8 offset:200
    ds_read_b128 v[60:63], v12 offset:3776
    ds_read_b128 v[16:19], v12 offset:3840
    ds_read_b64 v[112:113], v8 offset:256
    ds_read_b64 v[114:115], v8 offset:264
    s_waitcnt lgkmcnt(12)
    v_mfma_f32_16x16x32_bf16 v[64:67], v[96:99], v[48:51], 0
    v_mfma_f32_16x16x32_bf16 v[64:67], v[44:47], v[48:51], v[64:67]
    ds_read_b128 v[20:23], v12 offset:3904
    ds_read_b64 v[116:117], v8 offset:320
    ds_read_b64 v[118:119], v8 offset:328
    s_waitcnt lgkmcnt(12)
    v_mfma_f32_16x16x32_bf16 v[64:67], v[100:103], v[52:55], v[64:67]
    ds_read_b128 v[24:27], v12 offset:3968
    ds_read_b64 v[120:121], v8 offset:384
    ds_read_b64 v[122:123], v8 offset:392
    s_waitcnt lgkmcnt(12)
    v_mfma_f32_16x16x32_bf16 v[64:67], v[104:107], v[56:59], v[64:67]
    ds_read_b128 v[28:31], v12 offset:4032
    ds_read_b64 v[124:125], v8 offset:448
    ds_read_b64 v[126:127], v8 offset:456
    s_waitcnt lgkmcnt(12)
    v_mfma_f32_16x16x32_bf16 v[64:67], v[108:111], v[60:63], v[64:67]
    s_bitcmp1_b32 s97, 1
    s_cbranch_scc0 L_spin_44
L_ok_43:
    ds_read_b128 v[32:35], v12 offset:3072
    s_waitcnt lgkmcnt(12)
    s_waitcnt lgkmcnt(10)
    v_mfma_f32_16x16x32_bf16 v[64:67], v[112:115], v[16:19], v[64:67]
    ds_read_b64 v[128:129], v8 offset:512
    ds_read_b64 v[130:131], v8 offset:520
    ds_read_b64 v[132:133], v8 offset:576
    ds_read_b64 v[134:135], v8 offset:584
    ds_read_b128 v[36:39], v12 offset:3136
    s_waitcnt lgkmcnt(14)
    s_waitcnt lgkmcnt(12)
    v_mfma_f32_16x16x32_bf16 v[64:67], v[116:119], v[20:23], v[64:67]
    ds_read_b64 v[136:137], v8 offset:640
    ds_read_b64 v[138:139], v8 offset:648
    ds_read_b64 v[140:141], v8 offset:704
    ds_read_b64 v[142:143], v8 offset:712
    ds_read_b128 v[40:43], v12 offset:3200
    s_waitcnt lgkmcnt(15)
    s_waitcnt lgkmcnt(14)
    v_mfma_f32_16x16x32_bf16 v[64:67], v[120:123], v[24:27], v[64:67]
    ds_read_b64 v[144:145], v8 offset:768
    ds_read_b64 v[146:147], v8 offset:776
    ds_read_b64 v[148:149], v8 offset:832
    ds_read_b64 v[150:151], v8 offset:840
    ds_read_b128 v[48:51], v12 offset:3264
    s_waitcnt lgkmcnt(15)
    v_mfma_f32_16x16x32_bf16 v[64:67], v[124:127], v[28:31], v[64:67]
    ds_read_b64 v[152:153], v8 offset:896
    ds_read_b64 v[154:155], v8 offset:904
    ds_read_b64 v[156:157], v8 offset:960
    ds_read_b64 v[158:159], v8 offset:968
    ds_read_b128 v[52:55], v12 offset:3328
    ds_read_b128 v[56:59], v12 offset:3392
    ds_read_b128 v[60:63], v12 offset:3456
    ds_read_b128 v[16:19], v12 offset:3520
    v_mfma_f32_16x16x32_bf16 v[68:71], v[96:99], v[32:35], 0
    v_mfma_f32_16x16x32_bf16 v[68:71], v[44:47], v[32:35], v[68:71]
    ds_read_b64 v[160:161], v8 offset:2560
    ds_read_b64 v[162:163], v8 offset:2568
    s_waitcnt lgkmcnt(15)
    v_mfma_f32_16x16x32_bf16 v[72:75], v[128:131], v[32:35], 0
    s_bitcmp1_b32 s97, 2
    s_cbranch_scc0 L_spin_46
L_ok_45:
    ds_read_b128 v[20:23], v12 offset:2560
    ds_read_b128 v[24:27], v12 offset:2624
    ds_read_b128 v[28:31], v12 offset:2688
    ds_read_b128 v[32:35], v12 offset:2752
    v_mfma_f32_16x16x32_bf16 v[68:71], v[100:103], v[36:39], v[68:71]
    ds_read_b64 v[164:165], v8 offset:2624
    ds_read_b64 v[166:167], v8 offset:2632
    v_mfma_f32_16x16x32_bf16 v[72:75], v[132:135], v[36:39], v[72:75]
    ds_read_b128 v[36:39], v12 offset:2816
    v_mfma_f32_16x16x32_bf16 v[68:71], v[104:107], v[40:43], v[68:71]
    ds_read_b64 v[168:169], v8 offset:2688
    ds_read_b64 v[170:171], v8 offset:2696
    v_mfma_f32_16x16x32_bf16 v[72:75], v[136:139], v[40:43], v[72:75]
    ds_read_b128 v[40:43], v12 offset:2880
    s_waitcnt lgkmcnt(15)
    v_mfma_f32_16x16x32_bf16 v[68:71], v[108:111], v[48:51], v[68:71]
    ds_read_b64 v[172:173], v8 offset:2752
    ds_read_b64 v[174:175], v8 offset:2760
    v_mfma_f32_16x16x32_bf16 v[72:75], v[140:143], v[48:51], v[72:75]
    ds_write_b128 v5, v[64:67] offset:0
    ds_add_u32 v13, v14 offset:32
    ds_read_b128 v[48:51], v12 offset:2944
    v_mfma_f32_16x16x32_bf16 v[68:71], v[112:115], v[52:55], v[68:71]
    ds_read_b64 v[176:177], v8 offset:2816
    ds_read_b64 v[178:179], v8 offset:2824
    v_mfma_f32_16x16x32_bf16 v[72:75], v[144:147], v[52:55], v[72:75]
    ds_read_b128 v[52:55], v12 offset:3008
    s_waitcnt lgkmcnt(15)
    v_mfma_f32_16x16x32_bf16 v[68:71], v[116:119], v[56:59], v[68:71]
    ds_read_b64 v[180:181], v8 offset:2880
    ds_read_b64 v[182:183], v8 offset:2888
    v_mfma_f32_16x16x32_bf16 v[72:75], v[148:151], v[56:59], v[72:75]
    v_mfma_f32_16x16x32_bf16 v[68:71], v[120:123], v[60:63], v[68:71]
    ds_read_b64 v[184:185], v8 offset:2944
    ds_read_b64 v[186:187], v8 offset:2952
    v_mfma_f32_16x16x32_bf16 v[72:75], v[152:155], v[60:63], v[72:75]
    v_mfma_f32_16x16x32_bf16 v[68:71], v[124:127], v[16:19], v[68:71]
    ds_read_b64 v[188:189], v8 offset:3008
    ds_read_b64 v[190:191], v8 offset:3016
    v_mfma_f32_16x16x32_bf16 v[72:75], v[156:159], v[16:19], v[72:75]
    s_bitcmp1_b32 s97, 0
    s_cbranch_scc0 L_spin_48
L_ok_47:
    ds_read_b128 v[56:59], v12 offset:3584
    ds_read_b128 v[60:63], v12 offset:3648
    ds_read_b128 v[16:19], v12 offset:3712
    v_mfma_f32_16x16x32_bf16 v[72:75], v[96:99], v[20:23], v[72:75]
    v_mfma_f32_16x16x32_bf16 v[72:75], v[44:47], v[20:23], v[72:75]
    v_mfma_f32_16x16x32_bf16 v[76:79], v[128:131], v[20:23], 0
    v_mfma_f32_16x16x32_bf16 v[92:95], v[160:163], v[20:23], 0
    ds_read_b128 v[20:23], v12 offset:3776
    v_mfma_f32_16x16x32_bf16 v[72:75], v[100:103], v[24:27], v[72:75]
    v_mfma_f32_16x16x32_bf16 v[76:79], v[132:135], v[24:27], v[76:79]
    s_waitcnt lgkmcnt(15)
    v_mfma_f32_16x16x32_bf16 v[92:95], v[164:167], v[24:27], v[92:95]
    ds_read_b128 v[24:27], v12 offset:3840
    v_mfma_f32_16x16x32_bf16 v[72:75], v[104:107], v[28:31], v[72:75]
    v_mfma_f32_16x16x32_bf16 v[76:79], v[136:139], v[28:31], v[76:79]
    v_mfma_f32_16x16x32_bf16 v[92:95], v[168:171], v[28:31], v[92:95]
    ds_read_b128 v[28:31], v12 offset:3904
    v_mfma_f32_16x16x32_bf16 v[72:75], v[108:111], v[32:35], v[72:75]
    v_mfma_f32_16x16x32_bf16 v[76:79], v[140:143], v[32:35], v[76:79]
    v_mfma_f32_16x16x32_bf16 v[92:95], v[172:175], v[32:35], v[92:95]
    ds_read_b128 v[32:35], v12 offset:3968
    v_mfma_f32_16x16x32_bf16 v[72:75], v[112:115], v[36:39], v[72:75]
    v_mfma_f32_16x16x32_bf16 v[76:79], v[144:147], v[36:39], v[76:79]
    s_waitcnt lgkmcnt(14)
    v_mfma_f32_16x16x32_bf16 v[92:95], v[176:179], v[36:39], v[92:95]
    ds_read_b128 v[36:39], v12 offset:4032
    v_mfma_f32_16x16x32_bf16 v[72:75], v[116:119], v[40:43], v[72:75]
    v_mfma_f32_16x16x32_bf16 v[76:79], v[148:151], v[40:43], v[76:79]
    s_waitcnt lgkmcnt(12)
    v_mfma_f32_16x16x32_bf16 v[92:95], v[180:183], v[40:43], v[92:95]
    v_mfma_f32_16x16x32_bf16 v[72:75], v[120:123], v[48:51], v[72:75]
    v_mfma_f32_16x16x32_bf16 v[76:79], v[152:155], v[48:51], v[76:79]
    s_waitcnt lgkmcnt(10)
    v_mfma_f32_16x16x32_bf16 v[92:95], v[184:187], v[48:51], v[92:95]
    v_mfma_f32_16x16x32_bf16 v[72:75], v[124:127], v[52:55], v[72:75]
    v_mfma_f32_16x16x32_bf16 v[76:79], v[156:159], v[52:55], v[76:79]
    s_waitcnt lgkmcnt(8)
    v_mfma_f32_16x16x32_bf16 v[92:95], v[188:191], v[52:55], v[92:95]
    s_bitcmp1_b32 s97, 1
    s_cbranch_scc0 L_spin_50
L_ok_49:
    ds_read_b128 v[40:43], v12 offset:3072
    ds_read_b128 v[48:51], v12 offset:3136
    ds_read_b128 v[52:55], v12 offset:3200
    s_waitcnt lgkmcnt(10)
    v_mfma_f32_16x16x32_bf16 v[68:71], v[128:131], v[56:59], v[68:71]
    v_mfma_f32_16x16x32_bf16 v[84:87], v[160:163], v[56:59], 0
    ds_read_b128 v[56:59], v12 offset:3264
    s_waitcnt lgkmcnt(10)
    v_mfma_f32_16x16x32_bf16 v[68:71], v[132:135], v[60:63], v[68:71]
    v_mfma_f32_16x16x32_bf16 v[84:87], v[164:167], v[60:63], v[84:87]
    ds_read_b128 v[60:63], v12 offset:3328
    s_waitcnt lgkmcnt(10)
    v_mfma_f32_16x16x32_bf16 v[68:71], v[136:139], v[16:19], v[68:71]
    v_mfma_f32_16x16x32_bf16 v[84:87], v[168:171], v[16:19], v[84:87]
    ds_read_b128 v[16:19], v12 offset:3392
    s_waitcnt lgkmcnt(10)
    v_mfma_f32_16x16x32_bf16 v[68:71], v[140:143], v[20:23], v[68:71]
    v_mfma_f32_16x16x32_bf16 v[84:87], v[172:175], v[20:23], v[84:87]
    ds_write_b128 v5, v[72:75] offset:2048
    ds_add_u32 v13, v14 offset:40
    ds_read_b128 v[20:23], v12 offset:3456
    s_waitcnt lgkmcnt(12)
    v_mfma_f32_16x16x32_bf16 v[68:71], v[144:147], v[24:27], v[68:71]
    v_mfma_f32_16x16x32_bf16 v[84:87], v[176:179], v[24:27], v[84:87]
    ds_read_b128 v[24:27], v12 offset:3520
    s_waitcnt lgkmcnt(12)
    v_mfma_f32_16x16x32_bf16 v[68:71], v[148:151], v[28:31], v[68:71]
    v_mfma_f32_16x16x32_bf16 v[84:87], v[180:183], v[28:31], v[84:87]
    s_waitcnt lgkmcnt(11)
    v_mfma_f32_16x16x32_bf16 v[68:71], v[152:155], v[32:35], v[68:71]
    v_mfma_f32_16x16x32_bf16 v[84:87], v[184:187], v[32:35], v[84:87]
    s_waitcnt lgkmcnt(10)
    v_mfma_f32_16x16x32_bf16 v[68:71], v[156:159], v[36:39], v[68:71]
    v_mfma_f32_16x16x32_bf16 v[84:87], v[188:191], v[36:39], v[84:87]
    s_bitcmp1_b32 s97, 3
    s_cbranch_scc0 L_spin_52
L_ok_51:
    ds_read_b128 v[28:31], v12 offset:2048
    ds_read_b128 v[32:35], v12 offset:2112
    ds_read_b128 v[36:39], v12 offset:2176
    s_waitcnt lgkmcnt(12)
    v_mfma_f32_16x16x32_bf16 v[88:91], v[160:163], v[40:43], 0
    ds_read_b128 v[40:43], v12 offset:2240
    s_waitcnt lgkmcnt(12)
    v_mfma_f32_16x16x32_bf16 v[88:91], v[164:167], v[48:51], v[88:91]
    ds_read_b128 v[48:51], v12 offset:2304
    s_waitcnt lgkmcnt(12)
    v_mfma_f32_16x16x32_bf16 v[88:91], v[168:171], v[52:55], v[88:91]
    ds_read_b128 v[52:55], v12 offset:2368
    s_waitcnt lgkmcnt(12)
    v_mfma_f32_16x16x32_bf16 v[88:91], v[172:175], v[56:59], v[88:91]
    ds_read_b128 v[56:59], v12 offset:2432
    s_waitcnt lgkmcnt(12)
    v_mfma_f32_16x16x32_bf16 v[88:91], v[176:179], v[60:63], v[88:91]
    ds_read_b128 v[60:63], v12 offset:2496
    s_waitcnt lgkmcnt(12)
    v_mfma_f32_16x16x32_bf16 v[88:91], v[180:183], v[16:19], v[88:91]
    s_waitcnt lgkmcnt(9)
    v_mfma_f32_16x16x32_bf16 v[88:91], v[184:187], v[20:23], v[88:91]
    s_waitcnt lgkmcnt(8)
    v_mfma_f32_16x16x32_bf16 v[88:91], v[188:191], v[24:27], v[88:91]
    ds_write_b128 v5, v[68:71] offset:1024
    ds_add_u32 v13, v14 offset:36
    s_bitcmp1_b32 s97, 4
    s_cbranch_scc0 L_spin_54
L_ok_53:
    ds_read_b128 v[16:19], v12 offset:1536
    ds_read_b128 v[20:23], v12 offset:1600
    ds_read_b128 v[24:27], v12 offset:1664
    s_waitcnt lgkmcnt(12)
    v_mfma_f32_16x16x32_bf16 v[76:79], v[96:99], v[28:31], v[76:79]
    v_mfma_f32_16x16x32_bf16 v[76:79], v[44:47], v[28:31], v[76:79]
    v_mfma_f32_16x16x32_bf16 v[80:83], v[128:131], v[28:31], 0
    ds_read_b128 v[28:31], v12 offset:1728
    s_waitcnt lgkmcnt(12)
    v_mfma_f32_16x16x32_bf16 v[76:79], v[100:103], v[32:35], v[76:79]
    v_mfma_f32_16x16x32_bf16 v[80:83], v[132:135], v[32:35], v[80:83]
    ds_read_b128 v[32:35], v12 offset:1792
    s_waitcnt lgkmcnt(12)
    v_mfma_f32_16x16x32_bf16 v[76:79], v[104:107], v[36:39], v[76:79]
    v_mfma_f32_16x16x32_bf16 v[80:83], v[136:139], v[36:39], v[80:83]
    ds_read_b128 v[36:39], v12 offset:1856
    s_waitcnt lgkmcnt(12)
    v_mfma_f32_16x16x32_bf16 v[76:79], v[108:111], v[40:43], v[76:79]
    v_mfma_f32_16x16x32_bf16 v[80:83], v[140:143], v[40:43], v[80:83]
    ds_read_b128 v[40:43], v12 offset:1920
    s_waitcnt lgkmcnt(12)
    v_mfma_f32_16x16x32_bf16 v[76:79], v[112:115], v[48:51], v[76:79]
    v_mfma_f32_16x16x32_bf16 v[80:83], v[144:147], v[48:51], v[80:83]
    ds_read_b128 v[48:51], v12 offset:1984
    s_waitcnt lgkmcnt(12)
    v_mfma_f32_16x16x32_bf16 v[76:79], v[116:119], v[52:55], v[76:79]
    v_mfma_f32_16x16x32_bf16 v[80:83], v[148:151], v[52:55], v[80:83]
    s_waitcnt lgkmcnt(11)
    v_mfma_f32_16x16x32_bf16 v[76:79], v[120:123], v[56:59], v[76:79]
    v_mfma_f32_16x16x32_bf16 v[80:83], v[152:155], v[56:59], v[80:83]
    s_waitcnt lgkmcnt(10)
    v_mfma_f32_16x16x32_bf16 v[76:79], v[124:127], v[60:63], v[76:79]
    v_mfma_f32_16x16x32_bf16 v[80:83], v[156:159], v[60:63], v[80:83]
    s_bitcmp1_b32 s97, 5
    s_cbranch_scc0 L_spin_56
L_ok_55:
    ds_read_b128 v[52:55], v12 offset:1024
    ds_read_b128 v[56:59], v12 offset:1088
    ds_read_b128 v[60:63], v12 offset:1152
    s_waitcnt lgkmcnt(10)
    v_mfma_f32_16x16x32_bf16 v[80:83], v[96:99], v[16:19], v[80:83]
    v_mfma_f32_16x16x32_bf16 v[80:83], v[44:47], v[16:19], v[80:83]
    v_mfma_f32_16x16x32_bf16 v[84:87], v[128:131], v[16:19], v[84:87]
    ds_read_b128 v[16:19], v12 offset:1216
    s_waitcnt lgkmcnt(10)
    v_mfma_f32_16x16x32_bf16 v[80:83], v[100:103], v[20:23], v[80:83]
    v_mfma_f32_16x16x32_bf16 v[84:87], v[132:135], v[20:23], v[84:87]
    ds_read_b128 v[20:23], v12 offset:1280
    s_waitcnt lgkmcnt(10)
    v_mfma_f32_16x16x32_bf16 v[80:83], v[104:107], v[24:27], v[80:83]
    v_mfma_f32_16x16x32_bf16 v[84:87], v[136:139], v[24:27], v[84:87]
    ds_read_b128 v[24:27], v12 offset:1344
    s_waitcnt lgkmcnt(10)
    v_mfma_f32_16x16x32_bf16 v[80:83], v[108:111], v[28:31], v[80:83]
    v_mfma_f32_16x16x32_bf16 v[84:87], v[140:143], v[28:31], v[84:87]
    ds_write_b128 v5, v[76:79] offset:3072
    ds_add_u32 v13, v14 offset:44
    ds_read_b128 v[28:31], v12 offset:1408
    s_waitcnt lgkmcnt(12)
    v_mfma_f32_16x16x32_bf16 v[80:83], v[112:115], v[32:35], v[80:83]
    v_mfma_f32_16x16x32_bf16 v[84:87], v[144:147], v[32:35], v[84:87]
    ds_read_b128 v[32:35], v12 offset:1472
    s_waitcnt lgkmcnt(12)
    v_mfma_f32_16x16x32_bf16 v[80:83], v[116:119], v[36:39], v[80:83]
    v_mfma_f32_16x16x32_bf16 v[84:87], v[148:151], v[36:39], v[84:87]
    s_waitcnt lgkmcnt(11)
    v_mfma_f32_16x16x32_bf16 v[80:83], v[120:123], v[40:43], v[80:83]
    v_mfma_f32_16x16x32_bf16 v[84:87], v[152:155], v[40:43], v[84:87]
    s_waitcnt lgkmcnt(10)
    v_mfma_f32_16x16x32_bf16 v[80:83], v[124:127], v[48:51], v[80:83]
    v_mfma_f32_16x16x32_bf16 v[84:87], v[156:159], v[48:51], v[84:87]
    s_bitcmp1_b32 s97, 6
    s_cbranch_scc0 L_spin_58
L_ok_57:
    ds_read_b128 v[36:39], v12 offset:512
    ds_read_b128 v[40:43], v12 offset:576
    ds_read_b128 v[48:51], v12 offset:640
    s_waitcnt lgkmcnt(12)
    v_mfma_f32_16x16x32_bf16 v[84:87], v[96:99], v[52:55], v[84:87]
    v_mfma_f32_16x16x32_bf16 v[84:87], v[44:47], v[52:55], v[84:87]
    v_mfma_f32_16x16x32_bf16 v[88:91], v[128:131], v[52:55], v[88:91]
    ds_read_b128 v[52:55], v12 offset:704
    s_waitcnt lgkmcnt(12)
    v_mfma_f32_16x16x32_bf16 v[84:87], v[100:103], v[56:59], v[84:87]
    v_mfma_f32_16x16x32_bf16 v[88:91], v[132:135], v[56:59], v[88:91]
    ds_read_b128 v[56:59], v12 offset:768
    s_waitcnt lgkmcnt(12)
    v_mfma_f32_16x16x32_bf16 v[84:87], v[104:107], v[60:63], v[84:87]
    v_mfma_f32_16x16x32_bf16 v[88:91], v[136:139], v[60:63], v[88:91]
    ds_read_b128 v[60:63], v12 offset:832
    s_waitcnt lgkmcnt(12)
    v_mfma_f32_16x16x32_bf16 v[84:87], v[108:111], v[16:19], v[84:87]
    v_mfma_f32_16x16x32_bf16 v[88:91], v[140:143], v[16:19], v[88:91]
    ds_write_b128 v5, v[80:83] offset:4096
    ds_add_u32 v13, v14 offset:48
    ds_read_b128 v[16:19], v12 offset:896
    s_waitcnt lgkmcnt(14)
    v_mfma_f32_16x16x32_bf16 v[84:87], v[112:115], v[20:23], v[84:87]
    v_mfma_f32_16x16x32_bf16 v[88:91], v[144:147], v[20:23], v[88:91]
    ds_read_b128 v[20:23], v12 offset:960
    s_waitcnt lgkmcnt(14)
    v_mfma_f32_16x16x32_bf16 v[84:87], v[116:119], v[24:27], v[84:87]
    v_mfma_f32_16x16x32_bf16 v[88:91], v[148:151], v[24:27], v[88:91]
    s_waitcnt lgkmcnt(11)
    v_mfma_f32_16x16x32_bf16 v[84:87], v[120:123], v[28:31], v[84:87]
    v_mfma_f32_16x16x32_bf16 v[88:91], v[152:155], v[28:31], v[88:91]
    s_waitcnt lgkmcnt(10)
    v_mfma_f32_16x16x32_bf16 v[84:87], v[124:127], v[32:35], v[84:87]
    v_mfma_f32_16x16x32_bf16 v[88:91], v[156:159], v[32:35], v[88:91]
    s_bitcmp1_b32 s97, 7
    s_cbranch_scc0 L_spin_60
L_ok_59:
    ds_read_b128 v[24:27], v12 offset:0
    ds_read_b128 v[28:31], v12 offset:64
    ds_read_b128 v[32:35], v12 offset:128
    s_waitcnt lgkmcnt(12)
    v_mfma_f32_16x16x32_bf16 v[88:91], v[96:99], v[36:39], v[88:91]
    v_mfma_f32_16x16x32_bf16 v[88:91], v[44:47], v[36:39], v[88:91]
    v_mfma_f32_16x16x32_bf16 v[92:95], v[128:131], v[36:39], v[92:95]
    ds_read_b128 v[36:39], v12 offset:192
    s_waitcnt lgkmcnt(12)
    v_mfma_f32_16x16x32_bf16 v[88:91], v[100:103], v[40:43], v[88:91]
    v_mfma_f32_16x16x32_bf16 v[92:95], v[132:135], v[40:43], v[92:95]
    ds_read_b128 v[40:43], v12 offset:256
    s_waitcnt lgkmcnt(12)
    v_mfma_f32_16x16x32_bf16 v[88:91], v[104:107], v[48:51], v[88:91]
    v_mfma_f32_16x16x32_bf16 v[92:95], v[136:139], v[48:51], v[92:95]
    ds_read_b128 v[48:51], v12 offset:320
    s_waitcnt lgkmcnt(12)
    v_mfma_f32_16x16x32_bf16 v[88:91], v[108:111], v[52:55], v[88:91]
    v_mfma_f32_16x16x32_bf16 v[92:95], v[140:143], v[52:55], v[92:95]
    ds_write_b128 v5, v[84:87] offset:5120
    ds_add_u32 v13, v14 offset:52
    ds_read_b128 v[52:55], v12 offset:384
    s_waitcnt lgkmcnt(14)
    v_mfma_f32_16x16x32_bf16 v[88:91], v[112:115], v[56:59], v[88:91]
    v_mfma_f32_16x16x32_bf16 v[92:95], v[144:147], v[56:59], v[92:95]
    ds_read_b128 v[56:59], v12 offset:448
    s_waitcnt lgkmcnt(14)
    v_mfma_f32_16x16x32_bf16 v[88:91], v[116:119], v[60:63], v[88:91]
    v_mfma_f32_16x16x32_bf16 v[92:95], v[148:151], v[60:63], v[92:95]
    s_waitcnt lgkmcnt(11)
    v_mfma_f32_16x16x32_bf16 v[88:91], v[120:123], v[16:19], v[88:91]
    v_mfma_f32_16x16x32_bf16 v[92:95], v[152:155], v[16:19], v[92:95]
    s_waitcnt lgkmcnt(10)
    v_mfma_f32_16x16x32_bf16 v[88:91], v[124:127], v[20:23], v[88:91]
    v_mfma_f32_16x16x32_bf16 v[92:95], v[156:159], v[20:23], v[92:95]
    s_waitcnt lgkmcnt(9)
    v_mfma_f32_16x16x32_bf16 v[92:95], v[96:99], v[24:27], v[92:95]
    v_mfma_f32_16x16x32_bf16 v[92:95], v[44:47], v[24:27], v[92:95]
    s_waitcnt lgkmcnt(8)
    v_mfma_f32_16x16x32_bf16 v[92:95], v[100:103], v[28:31], v[92:95]
    s_waitcnt lgkmcnt(7)
    v_mfma_f32_16x16x32_bf16 v[92:95], v[104:107], v[32:35], v[92:95]
    s_waitcnt lgkmcnt(6)
    v_mfma_f32_16x16x32_bf16 v[92:95], v[108:111], v[36:39], v[92:95]
    s_waitcnt lgkmcnt(5)
    v_mfma_f32_16x16x32_bf16 v[92:95], v[112:115], v[40:43], v[92:95]
    s_waitcnt lgkmcnt(4)
    v_mfma_f32_16x16x32_bf16 v[92:95], v[116:119], v[48:51], v[92:95]
    s_waitcnt lgkmcnt(1)
    v_mfma_f32_16x16x32_bf16 v[92:95], v[120:123], v[52:55], v[92:95]
    s_waitcnt lgkmcnt(0)
    v_mfma_f32_16x16x32_bf16 v[92:95], v[124:127], v[56:59], v[92:95]
    ds_write_b128 v5, v[88:91] offset:6144
    ds_add_u32 v13, v14 offset:56
    s_nop 7
    ds_write_b128 v5, v[92:95] offset:7168
    ds_add_u32 v13, v14 offset:60
    s_branch L_B_fin
L_B_h1:
    s_bitcmp1_b32 s97, 0
    s_cbranch_scc0 L_spin_62
L_ok_61:
    ds_read_b64 v[96:97], v8 offset:1024
    ds_read_b64 v[98:99], v8 offset:1032
    ds_read_b128 v[48:51], v12 offset:3584
    ds_read_b64 v[100:101], v8 offset:1088
    ds_read_b64 v[102:103], v8 offset:1096
    ds_read_b128 v[52:55], v12 offset:3648
    ds_read_b64 v[104:105], v8 offset:1152
    ds_read_b64 v[106:107], v8 offset:1160
    ds_read_b128 v[56:59], v12 offset:3712
    ds_read_b64 v[108:109], v8 offset:1216
    ds_read_b64 v[110:111], v8 offset:1224
    ds_read_b128 v[60:63], v12 offset:3776
    ds_read_b128 v[16:19], v12 offset:3840
    ds_read_b64 v[112:113], v8 offset:1280
    ds_read_b64 v[114:115], v8 offset:1288
    s_waitcnt lgkmcnt(12)
    v_mfma_f32_16x16x32_bf16 v[72:75], v[96:99], v[48:51], 0
    ds_read_b128 v[20:23], v12 offset:3904
    ds_read_b64 v[116:117], v8 offset:1344
    ds_read_b64 v[118:119], v8 offset:1352
    s_waitcnt lgkmcnt(12)
    v_mfma_f32_16x16x32_bf16 v[72:75], v[100:103], v[52:55], v[72:75]
    ds_read_b128 v[24:27], v12 offset:3968
    ds_read_b64 v[120:121], v8 offset:1408
    ds_read_b64 v[122:123], v8 offset:1416
    s_waitcnt lgkmcnt(12)
    v_mfma_f32_16x16x32_bf16 v[72:75], v[104:107], v[56:59], v[72:75]
    ds_read_b128 v[28:31], v12 offset:4032
    ds_read_b64 v[124:125], v8 offset:1472
    ds_read_b64 v[126:127], v8 offset:1480
    s_waitcnt lgkmcnt(12)
    v_mfma_f32_16x16x32_bf16 v[72:75], v[108:111], v[60:63], v[72:75]
    s_bitcmp1_b32 s97, 1
    s_cbranch_scc0 L_spin_64
L_ok_63:
    ds_read_b128 v[32:35], v12 offset:3072
    s_waitcnt lgkmcnt(12)
    s_waitcnt lgkmcnt(10)
    v_mfma_f32_16x16x32_bf16 v[72:75], v[112:115], v[16:19], v[72:75]
    ds_read_b64 v[128:129], v8 offset:1536
    ds_read_b64 v[130:131], v8 offset:1544
    ds_read_b64 v[132:133], v8 offset:1600
    ds_read_b64 v[134:135], v8 offset:1608
    ds_read_b128 v[36:39], v12 offset:3136
    s_waitcnt lgkmcnt(14)
    s_waitcnt lgkmcnt(12)
    v_mfma_f32_16x16x32_bf16 v[72:75], v[116:119], v[20:23], v[72:75]
    ds_read_b64 v[136:137], v8 offset:1664
    ds_read_b64 v[138:139], v8 offset:1672
    ds_read_b64 v[140:141], v8 offset:1728
    ds_read_b64 v[142:143], v8 offset:1736
    ds_read_b128 v[40:43], v12 offset:3200
    s_waitcnt lgkmcnt(15)
    s_waitcnt lgkmcnt(14)
    v_mfma_f32_16x16x32_bf16 v[72:75], v[120:123], v[24:27], v[72:75]
    ds_read_b64 v[144:145], v8 offset:1792
    ds_read_b64 v[146:147], v8 offset:1800
    ds_read_b64 v[148:149], v8 offset:1856
    ds_read_b64 v[150:151], v8 offset:1864
    ds_read_b128 v[48:51], v12 offset:3264
    s_waitcnt lgkmcnt(15)
    v_mfma_f32_16x16x32_bf16 v[72:75], v[124:127], v[28:31], v[72:75]
    ds_read_b64 v[152:153], v8 offset:1920
    ds_read_b64 v[154:155], v8 offset:1928
    ds_read_b64 v[156:157], v8 offset:1984
    ds_read_b64 v[158:159], v8 offset:1992
    ds_read_b128 v[52:55], v12 offset:3328
    ds_read_b128 v[56:59], v12 offset:3392
    ds_read_b128 v[60:63], v12 offset:3456
    ds_read_b128 v[16:19], v12 offset:3520
    v_mfma_f32_16x16x32_bf16 v[76:79], v[96:99], v[32:35], 0
    ds_read_b64 v[160:161], v8 offset:2048
    ds_read_b64 v[162:163], v8 offset:2056
    s_waitcnt lgkmcnt(15)
    v_mfma_f32_16x16x32_bf16 v[80:83], v[128:131], v[32:35], 0
    s_bitcmp1_b32 s97, 2
    s_cbranch_scc0 L_spin_66
L_ok_65:
    ds_read_b128 v[20:23], v12 offset:2560
    ds_read_b128 v[24:27], v12 offset:2624
    ds_read_b128 v[28:31], v12 offset:2688
    ds_read_b128 v[32:35], v12 offset:2752
    v_mfma_f32_16x16x32_bf16 v[76:79], v[100:103], v[36:39], v[76:79]
    ds_read_b64 v[164:165], v8 offset:2112
    ds_read_b64 v[166:167], v8 offset:2120
    v_mfma_f32_16x16x32_bf16 v[80:83], v[132:135], v[36:39], v[80:83]
    ds_read_b128 v[36:39], v12 offset:2816
    v_mfma_f32_16x16x32_bf16 v[76:79], v[104:107], v[40:43], v[76:79]
    ds_read_b64 v[168:169], v8 offset:2176
    ds_read_b64 v[170:171], v8 offset:2184
    v_mfma_f32_16x16x32_bf16 v[80:83], v[136:139], v[40:43], v[80:83]
    ds_read_b128 v[40:43], v12 offset:2880
    s_waitcnt lgkmcnt(15)
    v_mfma_f32_16x16x32_bf16 v[76:79], v[108:111], v[48:51], v[76:79]
    ds_read_b64 v[172:173], v8 offset:2240
    ds_read_b64 v[174:175], v8 offset:2248
    v_mfma_f32_16x16x32_bf16 v[80:83], v[140:143], v[48:51], v[80:83]
    ds_write_b128 v5, v[72:75] offset:2048
    ds_add_u32 v13, v14 offset:40
    ds_read_b128 v[48:51], v12 offset:2944
    v_mfma_f32_16x16x32_bf16 v[76:79], v[112:115], v[52:55], v[76:79]
    ds_read_b64 v[176:177], v8 offset:2304
    ds_read_b64 v[178:179], v8 offset:2312
    v_mfma_f32_16x16x32_bf16 v[80:83], v[144:147], v[52:55], v[80:83]
    ds_read_b128 v[52:55], v12 offset:3008
    s_waitcnt lgkmcnt(15)
    v_mfma_f32_16x16x32_bf16 v[76:79], v[116:119], v[56:59], v[76:79]
    ds_read_b64 v[180:181], v8 offset:2368
    ds_read_b64 v[182:183], v8 offset:2376
    v_mfma_f32_16x16x32_bf16 v[80:83], v[148:151], v[56:59], v[80:83]
    v_mfma_f32_16x16x32_bf16 v[76:79], v[120:123], v[60:63], v[76:79]
    ds_read_b64 v[184:185], v8 offset:2432
    ds_read_b64 v[186:187], v8 offset:2440
    v_mfma_f32_16x16x32_bf16 v[80:83], v[152:155], v[60:63], v[80:83]
    v_mfma_f32_16x16x32_bf16 v[76:79], v[124:127], v[16:19], v[76:79]
    ds_read_b64 v[188:189], v8 offset:2496
    ds_read_b64 v[190:191], v8 offset:2504
    v_mfma_f32_16x16x32_bf16 v[80:83], v[156:159], v[16:19], v[80:83]
    s_bitcmp1_b32 s97, 3
    s_cbranch_scc0 L_spin_68
L_ok_67:
    ds_read_b128 v[56:59], v12 offset:2048
    ds_read_b128 v[60:63], v12 offset:2112
    ds_read_b128 v[16:19], v12 offset:2176
    v_mfma_f32_16x16x32_bf16 v[80:83], v[96:99], v[20:23], v[80:83]
    ds_read_b64 v[192:193], v8 offset:3072
    ds_read_b64 v[194:195], v8 offset:3080
    v_mfma_f32_16x16x32_bf16 v[84:87], v[128:131], v[20:23], 0
    v_mfma_f32_16x16x32_bf16 v[88:91], v[160:163], v[20:23], 0
    ds_read_b128 v[20:23], v12 offset:2240
    v_mfma_f32_16x16x32_bf16 v[80:83], v[100:103], v[24:27], v[80:83]
    ds_read_b64 v[196:197], v8 offset:3136
    ds_read_b64 v[198:199], v8 offset:3144
    v_mfma_f32_16x16x32_bf16 v[84:87], v[132:135], v[24:27], v[84:87]
    s_waitcnt lgkmcnt(15)
    v_mfma_f32_16x16x32_bf16 v[88:91], v[164:167], v[24:27], v[88:91]
    ds_read_b128 v[24:27], v12 offset:2304
    v_mfma_f32_16x16x32_bf16 v[80:83], v[104:107], v[28:31], v[80:83]
    ds_read_b64 v[200:201], v8 offset:3200
    ds_read_b64 v[202:203], v8 offset:3208
    v_mfma_f32_16x16x32_bf16 v[84:87], v[136:139], v[28:31], v[84:87]
    v_mfma_f32_16x16x32_bf16 v[88:91], v[168:171], v[28:31], v[88:91]
    ds_read_b128 v[28:31], v12 offset:2368
    v_mfma_f32_16x16x32_bf16 v[80:83], v[108:111], v[32:35], v[80:83]
    ds_read_b64 v[204:205], v8 offset:3264
    ds_read_b64 v[206:207], v8 offset:3272
    v_mfma_f32_16x16x32_bf16 v[84:87], v[140:143], v[32:35], v[84:87]
    v_mfma_f32_16x16x32_bf16 v[88:91], v[172:175], v[32:35], v[88:91]
    ds_read_b128 v[32:35], v12 offset:2432
    v_mfma_f32_16x16x32_bf16 v[80:83], v[112:115], v[36:39], v[80:83]
    ds_read_b64 v[208:209], v8 offset:3328
    ds_read_b64 v[210:211], v8 offset:3336
    v_mfma_f32_16x16x32_bf16 v[84:87], v[144:147], v[36:39], v[84:87]
    v_mfma_f32_16x16x32_bf16 v[88:91], v[176:179], v[36:39], v[88:91]
    ds_read_b128 v[36:39], v12 offset:2496
    v_mfma_f32_16x16x32_bf16 v[80:83], v[116:119], v[40:43], v[80:83]
    ds_read_b64 v[212:213], v8 offset:3392
    ds_read_b64 v[214:215], v8 offset:3400
    v_mfma_f32_16x16x32_bf16 v[84:87], v[148:151], v[40:43], v[84:87]
    s_waitcnt lgkmcnt(15)
    v_mfma_f32_16x16x32_bf16 v[88:91], v[180:183], v[40:43], v[88:91]
    v_mfma_f32_16x16x32_bf16 v[80:83], v[120:123], v[48:51], v[80:83]
    ds_read_b64 v[216:217], v8 offset:3456
    ds_read_b64 v[218:219], v8 offset:3464
    v_mfma_f32_16x16x32_bf16 v[84:87], v[152:155], v[48:51], v[84:87]
    v_mfma_f32_16x16x32_bf16 v[88:91], v[184:187], v[48:51], v[88:91]
    v_mfma_f32_16x16x32_bf16 v[80:83], v[124:127], v[52:55], v[80:83]
    ds_read_b64 v[220:221], v8 offset:3520
    ds_read_b64 v[222:223], v8 offset:3528
    v_mfma_f32_16x16x32_bf16 v[84:87], v[156:159], v[52:55], v[84:87]
    v_mfma_f32_16x16x32_bf16 v[88:91], v[188:191], v[52:55], v[88:91]
    s_bitcmp1_b32 s97, 0
    s_cbranch_scc0 L_spin_70
L_ok_69:
    ds_read_b128 v[40:43], v12 offset:3584
    ds_read_b128 v[48:51], v12 offset:3648
    ds_read_b128 v[52:55], v12 offset:3712
    v_mfma_f32_16x16x32_bf16 v[84:87], v[96:99], v[56:59], v[84:87]
    ds_read_b64 v[224:225], v8 offset:3584
    ds_read_b64 v[226:227], v8 offset:3592
    v_mfma_f32_16x16x32_bf16 v[88:91], v[128:131], v[56:59], v[88:91]
    v_mfma_f32_16x16x32_bf16 v[92:95], v[160:163], v[56:59], 0
    ds_read_b128 v[56:59], v12 offset:3776
    v_mfma_f32_16x16x32_bf16 v[84:87], v[100:103], v[60:63], v[84:87]
    ds_read_b64 v[228:229], v8 offset:3648
    ds_read_b64 v[230:231], v8 offset:3656
    v_mfma_f32_16x16x32_bf16 v[88:91], v[132:135], v[60:63], v[88:91]
    v_mfma_f32_16x16x32_bf16 v[92:95], v[164:167], v[60:63], v[92:95]
    ds_read_b128 v[60:63], v12 offset:3840
    v_mfma_f32_16x16x32_bf16 v[84:87], v[104:107], v[16:19], v[84:87]
    ds_read_b64 v[232:233], v8 offset:3712
    ds_read_b64 v[234:235], v8 offset:3720
    v_mfma_f32_16x16x32_bf16 v[88:91], v[136:139], v[16:19], v[88:91]
    v_mfma_f32_16x16x32_bf16 v[92:95], v[168:171], v[16:19], v[92:95]
    ds_read_b128 v[16:19], v12 offset:3904
    s_waitcnt lgkmcnt(15)
    v_mfma_f32_16x16x32_bf16 v[84:87], v[108:111], v[20:23], v[84:87]
    ds_read_b64 v[236:237], v8 offset:3776
    ds_read_b64 v[238:239], v8 offset:3784
    v_mfma_f32_16x16x32_bf16 v[88:91], v[140:143], v[20:23], v[88:91]
    v_mfma_f32_16x16x32_bf16 v[92:95], v[172:175], v[20:23], v[92:95]
    ds_read_b128 v[20:23], v12 offset:3968
    v_mfma_f32_16x16x32_bf16 v[84:87], v[112:115], v[24:27], v[84:87]
    ds_read_b64 v[240:241], v8 offset:3840
    ds_read_b64 v[242:243], v8 offset:3848
    v_mfma_f32_16x16x32_bf16 v[88:91], v[144:147], v[24:27], v[88:91]
    v_mfma_f32_16x16x32_bf16 v[92:95], v[176:179], v[24:27], v[92:95]
    ds_read_b128 v[24:27], v12 offset:4032
    v_mfma_f32_16x16x32_bf16 v[84:87], v[116:119], v[28:31], v[84:87]
    ds_read_b64 v[244:245], v8 offset:3904
    ds_read_b64 v[246:247], v8 offset:3912
    v_mfma_f32_16x16x32_bf16 v[88:91], v[148:151], v[28:31], v[88:91]
    v_mfma_f32_16x16x32_bf16 v[92:95], v[180:183], v[28:31], v[92:95]
    v_mfma_f32_16x16x32_bf16 v[84:87], v[120:123], v[32:35], v[84:87]
    ds_read_b64 v[248:249], v8 offset:3968
    ds_read_b64 v[250:251], v8 offset:3976
    v_mfma_f32_16x16x32_bf16 v[88:91], v[152:155], v[32:35], v[88:91]
    v_mfma_f32_16x16x32_bf16 v[92:95], v[184:187], v[32:35], v[92:95]
    v_mfma_f32_16x16x32_bf16 v[84:87], v[124:127], v[36:39], v[84:87]
    ds_read_b64 v[252:253], v8 offset:4032
    ds_read_b64 v[254:255], v8 offset:4040
    v_mfma_f32_16x16x32_bf16 v[88:91], v[156:159], v[36:39], v[88:91]
    v_mfma_f32_16x16x32_bf16 v[92:95], v[188:191], v[36:39], v[92:95]
    s_bitcmp1_b32 s97, 1
    s_cbranch_scc0 L_spin_72
L_ok_71:
    ds_read_b128 v[28:31], v12 offset:3072
    ds_read_b128 v[32:35], v12 offset:3136
    ds_read_b128 v[36:39], v12 offset:3200
    s_waitcnt lgkmcnt(15)
    v_mfma_f32_16x16x32_bf16 v[76:79], v[128:131], v[40:43], v[76:79]
    v_mfma_f32_16x16x32_bf16 v[80:83], v[160:163], v[40:43], v[80:83]
    v_mfma_f32_16x16x32_bf16 v[88:91], v[192:195], v[40:43], v[88:91]
    v_mfma_f32_16x16x32_bf16 v[92:95], v[224:227], v[40:43], v[92:95]
    ds_read_b128 v[40:43], v12 offset:3264
    v_mfma_f32_16x16x32_bf16 v[76:79], v[132:135], v[48:51], v[76:79]
    v_mfma_f32_16x16x32_bf16 v[80:83], v[164:167], v[48:51], v[80:83]
    v_mfma_f32_16x16x32_bf16 v[88:91], v[196:199], v[48:51], v[88:91]
    v_mfma_f32_16x16x32_bf16 v[92:95], v[228:231], v[48:51], v[92:95]
    ds_read_b128 v[48:51], v12 offset:3328
    v_mfma_f32_16x16x32_bf16 v[76:79], v[136:139], v[52:55], v[76:79]
    v_mfma_f32_16x16x32_bf16 v[80:83], v[168:171], v[52:55], v[80:83]
    v_mfma_f32_16x16x32_bf16 v[88:91], v[200:203], v[52:55], v[88:91]
    v_mfma_f32_16x16x32_bf16 v[92:95], v[232:235], v[52:55], v[92:95]
    ds_read_b128 v[52:55], v12 offset:3392
    v_mfma_f32_16x16x32_bf16 v[76:79], v[140:143], v[56:59], v[76:79]
    v_mfma_f32_16x16x32_bf16 v[80:83], v[172:175], v[56:59], v[80:83]
    v_mfma_f32_16x16x32_bf16 v[88:91], v[204:207], v[56:59], v[88:91]
    s_waitcnt lgkmcnt(15)
    v_mfma_f32_16x16x32_bf16 v[92:95], v[236:239], v[56:59], v[92:95]
    ds_read_b128 v[56:59], v12 offset:3456
    v_mfma_f32_16x16x32_bf16 v[76:79], v[144:147], v[60:63], v[76:79]
    v_mfma_f32_16x16x32_bf16 v[80:83], v[176:179], v[60:63], v[80:83]
    v_mfma_f32_16x16x32_bf16 v[88:91], v[208:211], v[60:63], v[88:91]
    s_waitcnt lgkmcnt(14)
    v_mfma_f32_16x16x32_bf16 v[92:95], v[240:243], v[60:63], v[92:95]
    ds_read_b128 v[60:63], v12 offset:3520
    v_mfma_f32_16x16x32_bf16 v[76:79], v[148:151], v[16:19], v[76:79]
    v_mfma_f32_16x16x32_bf16 v[80:83], v[180:183], v[16:19], v[80:83]
    v_mfma_f32_16x16x32_bf16 v[88:91], v[212:215], v[16:19], v[88:91]
    s_waitcnt lgkmcnt(12)
    v_mfma_f32_16x16x32_bf16 v[92:95], v[244:247], v[16:19], v[92:95]
    v_mfma_f32_16x16x32_bf16 v[76:79], v[152:155], v[20:23], v[76:79]
    v_mfma_f32_16x16x32_bf16 v[80:83], v[184:187], v[20:23], v[80:83]
    v_mfma_f32_16x16x32_bf16 v[88:91], v[216:219], v[20:23], v[88:91]
    s_waitcnt lgkmcnt(10)
    v_mfma_f32_16x16x32_bf16 v[92:95], v[248:251], v[20:23], v[92:95]
    v_mfma_f32_16x16x32_bf16 v[76:79], v[156:159], v[24:27], v[76:79]
    v_mfma_f32_16x16x32_bf16 v[80:83], v[188:191], v[24:27], v[80:83]
    v_mfma_f32_16x16x32_bf16 v[88:91], v[220:223], v[24:27], v[88:91]
    s_waitcnt lgkmcnt(8)
    v_mfma_f32_16x16x32_bf16 v[92:95], v[252:255], v[24:27], v[92:95]
    s_bitcmp1_b32 s97, 4
    s_cbranch_scc0 L_spin_74
L_ok_73:
    ds_read_b128 v[16:19], v12 offset:1536
    ds_read_b128 v[20:23], v12 offset:1600
    ds_read_b128 v[24:27], v12 offset:1664
    s_waitcnt lgkmcnt(10)
    v_mfma_f32_16x16x32_bf16 v[84:87], v[160:163], v[28:31], v[84:87]
    v_mfma_f32_16x16x32_bf16 v[92:95], v[192:195], v[28:31], v[92:95]
    ds_read_b128 v[28:31], v12 offset:1728
    s_waitcnt lgkmcnt(10)
    v_mfma_f32_16x16x32_bf16 v[84:87], v[164:167], v[32:35], v[84:87]
    v_mfma_f32_16x16x32_bf16 v[92:95], v[196:199], v[32:35], v[92:95]
    ds_read_b128 v[32:35], v12 offset:1792
    s_waitcnt lgkmcnt(10)
    v_mfma_f32_16x16x32_bf16 v[84:87], v[168:171], v[36:39], v[84:87]
    v_mfma_f32_16x16x32_bf16 v[92:95], v[200:203], v[36:39], v[92:95]
    ds_read_b128 v[36:39], v12 offset:1856
    s_waitcnt lgkmcnt(10)
    v_mfma_f32_16x16x32_bf16 v[84:87], v[172:175], v[40:43], v[84:87]
    v_mfma_f32_16x16x32_bf16 v[92:95], v[204:207], v[40:43], v[92:95]
    ds_write_b128 v5, v[76:79] offset:3072
    ds_add_u32 v13, v14 offset:44
    ds_write_b128 v5, v[80:83] offset:4096
    ds_add_u32 v13, v14 offset:48
    ds_read_b128 v[40:43], v12 offset:1920
    s_waitcnt lgkmcnt(14)
    v_mfma_f32_16x16x32_bf16 v[84:87], v[176:179], v[48:51], v[84:87]
    v_mfma_f32_16x16x32_bf16 v[92:95], v[208:211], v[48:51], v[92:95]
    ds_read_b128 v[48:51], v12 offset:1984
    s_waitcnt lgkmcnt(14)
    v_mfma_f32_16x16x32_bf16 v[84:87], v[180:183], v[52:55], v[84:87]
    v_mfma_f32_16x16x32_bf16 v[92:95], v[212:215], v[52:55], v[92:95]
    s_waitcnt lgkmcnt(13)
    v_mfma_f32_16x16x32_bf16 v[84:87], v[184:187], v[56:59], v[84:87]
    v_mfma_f32_16x16x32_bf16 v[92:95], v[216:219], v[56:59], v[92:95]
    s_waitcnt lgkmcnt(12)
    v_mfma_f32_16x16x32_bf16 v[84:87], v[188:191], v[60:63], v[84:87]
    v_mfma_f32_16x16x32_bf16 v[92:95], v[220:223], v[60:63], v[92:95]
    s_bitcmp1_b32 s97, 5
    s_cbranch_scc0 L_spin_76
L_ok_75:
    ds_read_b128 v[52:55], v12 offset:1024
    ds_read_b128 v[56:59], v12 offset:1088
    ds_read_b128 v[60:63], v12 offset:1152
    s_waitcnt lgkmcnt(14)
    v_mfma_f32_16x16x32_bf16 v[88:91], v[96:99], v[16:19], v[88:91]
    v_mfma_f32_16x16x32_bf16 v[92:95], v[128:131], v[16:19], v[92:95]
    ds_read_b128 v[16:19], v12 offset:1216
    s_waitcnt lgkmcnt(14)
    v_mfma_f32_16x16x32_bf16 v[88:91], v[100:103], v[20:23], v[88:91]
    v_mfma_f32_16x16x32_bf16 v[92:95], v[132:135], v[20:23], v[92:95]
    ds_read_b128 v[20:23], v12 offset:1280
    s_waitcnt lgkmcnt(14)
    v_mfma_f32_16x16x32_bf16 v[88:91], v[104:107], v[24:27], v[88:91]
    v_mfma_f32_16x16x32_bf16 v[92:95], v[136:139], v[24:27], v[92:95]
    ds_read_b128 v[24:27], v12 offset:1344
    s_waitcnt lgkmcnt(14)
    v_mfma_f32_16x16x32_bf16 v[88:91], v[108:111], v[28:31], v[88:91]
    v_mfma_f32_16x16x32_bf16 v[92:95], v[140:143], v[28:31], v[92:95]
    ds_write_b128 v5, v[84:87] offset:5120
    ds_add_u32 v13, v14 offset:52
    ds_read_b128 v[28:31], v12 offset:1408
    s_waitcnt lgkmcnt(15)
    v_mfma_f32_16x16x32_bf16 v[88:91], v[112:115], v[32:35], v[88:91]
    v_mfma_f32_16x16x32_bf16 v[92:95], v[144:147], v[32:35], v[92:95]
    ds_read_b128 v[32:35], v12 offset:1472
    v_mfma_f32_16x16x32_bf16 v[88:91], v[116:119], v[36:39], v[88:91]
    v_mfma_f32_16x16x32_bf16 v[92:95], v[148:151], v[36:39], v[92:95]
    s_waitcnt lgkmcnt(11)
    v_mfma_f32_16x16x32_bf16 v[88:91], v[120:123], v[40:43], v[88:91]
    v_mfma_f32_16x16x32_bf16 v[92:95], v[152:155], v[40:43], v[92:95]
    s_waitcnt lgkmcnt(10)
    v_mfma_f32_16x16x32_bf16 v[88:91], v[124:127], v[48:51], v[88:91]
    v_mfma_f32_16x16x32_bf16 v[92:95], v[156:159], v[48:51], v[92:95]
    s_waitcnt lgkmcnt(9)
    v_mfma_f32_16x16x32_bf16 v[92:95], v[96:99], v[52:55], v[92:95]
    s_waitcnt lgkmcnt(8)
    v_mfma_f32_16x16x32_bf16 v[92:95], v[100:103], v[56:59], v[92:95]
    s_waitcnt lgkmcnt(7)
    v_mfma_f32_16x16x32_bf16 v[92:95], v[104:107], v[60:63], v[92:95]
    s_waitcnt lgkmcnt(6)
    v_mfma_f32_16x16x32_bf16 v[92:95], v[108:111], v[16:19], v[92:95]
    s_waitcnt lgkmcnt(5)
    v_mfma_f32_16x16x32_bf16 v[92:95], v[112:115], v[20:23], v[92:95]
    s_waitcnt lgkmcnt(4)
    v_mfma_f32_16x16x32_bf16 v[92:95], v[116:119], v[24:27], v[92:95]
    s_waitcnt lgkmcnt(1)
    v_mfma_f32_16x16x32_bf16 v[92:95], v[120:123], v[28:31], v[92:95]
    s_waitcnt lgkmcnt(0)
    v_mfma_f32_16x16x32_bf16 v[92:95], v[124:127], v[32:35], v[92:95]
    ds_write_b128 v5, v[88:91] offset:6144
    ds_add_u32 v13, v14 offset:56
    s_nop 7
    ds_write_b128 v5, v[92:95] offset:7168
    ds_add_u32 v13, v14 offset:60
L_B_fin:
    s_waitcnt lgkmcnt(0)
    s_cmp_ge_u32 s4, 4
    s_cbranch_scc1 L_B_done
    s_cmp_lt_u32 s4, 2
    s_cselect_b32 s7, 4, 8
    ds_read_b32 v15, v7 offset:32
    s_waitcnt lgkmcnt(0)
    v_readfirstlane_b32 s5, v15
    s_cmp_lt_u32 s5, s7
    s_cbranch_scc1 L_spin_78
L_ok_77:
    ds_read_b128 v[16:19], v6 offset:0
    ds_read_b128 v[20:23], v6 offset:17408
    ds_read_b128 v[24:27], v6 offset:34816
    ds_read_b128 v[28:31], v6 offset:52224
    v_lshlrev_b32 v2, 1, v3
    v_subrev_u32 v2, s6, v2
    v_add_u32 v2, 1280, v2
    s_cmp_lt_u32 s4, 2
    s_cbranch_scc1 L_sk_79
    ds_read_b128 v[32:35], v6 offset:8704
    ds_read_b128 v[36:39], v6 offset:26112
    ds_read_b128 v[40:43], v6 offset:43520
    ds_read_b128 v[44:47], v6 offset:60928
    s_waitcnt lgkmcnt(0)
    v_add_f32 v16, v16, v32
    v_add_f32 v17, v17, v33
    v_add_f32 v18, v18, v34
    v_add_f32 v19, v19, v35
    v_add_f32 v20, v20, v36
    v_add_f32 v21, v21, v37
    v_add_f32 v22, v22, v38
    v_add_f32 v23, v23, v39
    v_add_f32 v24, v24, v40
    v_add_f32 v25, v25, v41
    v_add_f32 v26, v26, v42
    v_add_f32 v27, v27, v43
    v_add_f32 v28, v28, v44
    v_add_f32 v29, v29, v45
    v_add_f32 v30, v30, v46
    v_add_f32 v31, v31, v47
L_sk_79:
    s_waitcnt lgkmcnt(0)
    v_cvt_pk_bf16_f32 v48, v16, v20
    v_cvt_pk_bf16_f32 v49, v24, v28
    buffer_store_dwordx2 v[48:49], v2, s[24:27], 0 offen offset:0
    v_cvt_pk_bf16_f32 v50, v17, v21
    v_cvt_pk_bf16_f32 v51, v25, v29
    buffer_store_dwordx2 v[50:51], v2, s[24:27], 0 offen offset:2560
    v_cvt_pk_bf16_f32 v52, v18, v22
    v_cvt_pk_bf16_f32 v53, v26, v30
    v_add_u32 v2, 5120, v2
    buffer_store_dwordx2 v[52:53], v2, s[24:27], 0 offen offset:0
    v_cvt_pk_bf16_f32 v54, v19, v23
    v_cvt_pk_bf16_f32 v55, v27, v31
    buffer_store_dwordx2 v[54:55], v2, s[24:27], 0 offen offset:2560
    s_mov_b32 s7, 8
    ds_read_b32 v15, v7 offset:48
    s_waitcnt lgkmcnt(0)
    v_readfirstlane_b32 s5, v15
    s_cmp_lt_u32 s5, s7
    s_cbranch_scc1 L_spin_81
L_ok_80:
    ds_read_b128 v[16:19], v6 offset:4096
    ds_read_b128 v[20:23], v6 offset:21504
    ds_read_b128 v[24:27], v6 offset:38912
    ds_read_b128 v[28:31], v6 offset:56320
    v_lshlrev_b32 v2, 1, v3
    v_subrev_u32 v2, s6, v2
    v_add_u32 v2, 2622720, v2
    ds_read_b128 v[32:35], v6 offset:12800
    ds_read_b128 v[36:39], v6 offset:30208
    ds_read_b128 v[40:43], v6 offset:47616
    ds_read_b128 v[44:47], v6 offset:65024
    s_waitcnt lgkmcnt(0)
    v_add_f32 v16, v16, v32
    v_add_f32 v17, v17, v33
    v_add_f32 v18, v18, v34
    v_add_f32 v19, v19, v35
    v_add_f32 v20, v20, v36
    v_add_f32 v21, v21, v37
    v_add_f32 v22, v22, v38
    v_add_f32 v23, v23, v39
    v_add_f32 v24, v24, v40
    v_add_f32 v25, v25, v41
    v_add_f32 v26, v26, v42
    v_add_f32 v27, v27, v43
    v_add_f32 v28, v28, v44
    v_add_f32 v29, v29, v45
    v_add_f32 v30, v30, v46
    v_add_f32 v31, v31, v47
L_sk_82:
    s_waitcnt lgkmcnt(0)
    v_cvt_pk_bf16_f32 v56, v16, v20
    v_cvt_pk_bf16_f32 v57, v24, v28
    buffer_store_dwordx2 v[56:57], v2, s[24:27], 0 offen offset:0
    v_cvt_pk_bf16_f32 v58, v17, v21
    v_cvt_pk_bf16_f32 v59, v25, v29
    buffer_store_dwordx2 v[58:59], v2, s[24:27], 0 offen offset:2560
    v_cvt_pk_bf16_f32 v60, v18, v22
    v_cvt_pk_bf16_f32 v61, v26, v30
    v_add_u32 v2, 5120, v2
    buffer_store_dwordx2 v[60:61], v2, s[24:27], 0 offen offset:0
    v_cvt_pk_bf16_f32 v62, v19, v23
    v_cvt_pk_bf16_f32 v63, v27, v31
    buffer_store_dwordx2 v[62:63], v2, s[24:27], 0 offen offset:2560
L_B_done:
    s_waitcnt vmcnt(0)
    s_endpgm
L_spin_2:
    s_mov_b32 s96, 0
L_spin_2_l:
    v_lshlrev_b32 v15, 2, v1
    v_and_b32 v15, 31, v15
    ds_read_b32 v15, v15 offset:0
    s_add_u32 s96, s96, 1
    s_cmp_gt_u32 s96, 0x40000
    s_cbranch_scc1 L_ok_1
    s_waitcnt lgkmcnt(0)
    v_cmp_ne_u32 vcc, 0, v15
    s_nop 1
    s_mov_b32 s97, vcc_lo
    s_bitcmp1_b32 s97, 0
    s_cbranch_scc1 L_ok_1
    s_sleep 1
    s_branch L_spin_2_l
L_spin_4:
    s_mov_b32 s96, 0
L_spin_4_l:
    v_lshlrev_b32 v15, 2, v1
    v_and_b32 v15, 31, v15
    ds_read_b32 v15, v15 offset:0
    s_add_u32 s96, s96, 1
    s_cmp_gt_u32 s96, 0x40000
    s_cbranch_scc1 L_ok_3
    s_waitcnt lgkmcnt(0)
    v_cmp_ne_u32 vcc, 0, v15
    s_nop 1
    s_mov_b32 s97, vcc_lo
    s_bitcmp1_b32 s97, 1
    s_cbranch_scc1 L_ok_3
    s_sleep 1
    s_branch L_spin_4_l
L_spin_6:
    s_mov_b32 s96, 0
L_spin_6_l:
    v_lshlrev_b32 v15, 2, v1
    v_and_b32 v15, 31, v15
    ds_read_b32 v15, v15 offset:0
    s_add_u32 s96, s96, 1
    s_cmp_gt_u32 s96, 0x40000
    s_cbranch_scc1 L_ok_5
    s_waitcnt lgkmcnt(0)
    v_cmp_ne_u32 vcc, 0, v15
    s_nop 1
    s_mov_b32 s97, vcc_lo
    s_bitcmp1_b32 s97, 2
    s_cbranch_scc1 L_ok_5
    s_sleep 1
    s_branch L_spin_6_l
L_spin_8:
    s_mov_b32 s96, 0
L_spin_8_l:
    v_lshlrev_b32 v15, 2, v1
    v_and_b32 v15, 31, v15
    ds_read_b32 v15, v15 offset:0
    s_add_u32 s96, s96, 1
    s_cmp_gt_u32 s96, 0x40000
    s_cbranch_scc1 L_ok_7
    s_waitcnt lgkmcnt(0)
    v_cmp_ne_u32 vcc, 0, v15
    s_nop 1
    s_mov_b32 s97, vcc_lo
    s_bitcmp1_b32 s97, 3
    s_cbranch_scc1 L_ok_7
    s_sleep 1
    s_branch L_spin_8_l
L_spin_10:
    s_mov_b32 s96, 0
L_spin_10_l:
    v_lshlrev_b32 v15, 2, v1
    v_and_b32 v15, 31, v15
    ds_read_b32 v15, v15 offset:0
    s_add_u32 s96, s96, 1
    s_cmp_gt_u32 s96, 0x40000
    s_cbranch_scc1 L_ok_9
    s_waitcnt lgkmcnt(0)
    v_cmp_ne_u32 vcc, 0, v15
    s_nop 1
    s_mov_b32 s97, vcc_lo
    s_bitcmp1_b32 s97, 4
    s_cbranch_scc1 L_ok_9
    s_sleep 1
    s_branch L_spin_10_l
L_spin_12:
    s_mov_b32 s96, 0
L_spin_12_l:
    v_lshlrev_b32 v15, 2, v1
    v_and_b32 v15, 31, v15
    ds_read_b32 v15, v15 offset:0
    s_add_u32 s96, s96, 1
    s_cmp_gt_u32 s96, 0x40000
    s_cbranch_scc1 L_ok_11
    s_waitcnt lgkmcnt(0)
    v_cmp_ne_u32 vcc, 0, v15
    s_nop 1
    s_mov_b32 s97, vcc_lo
    s_bitcmp1_b32 s97, 5
    s_cbranch_scc1 L_ok_11
    s_sleep 1
    s_branch L_spin_12_l
L_spin_14:
    s_mov_b32 s96, 0
L_spin_14_l:
    v_lshlrev_b32 v15, 2, v1
    v_and_b32 v15, 31, v15
    ds_read_b32 v15, v15 offset:0
    s_add_u32 s96, s96, 1
    s_cmp_gt_u32 s96, 0x40000
    s_cbranch_scc1 L_ok_13
    s_waitcnt lgkmcnt(0)
    v_cmp_ne_u32 vcc, 0, v15
    s_nop 1
    s_mov_b32 s97, vcc_lo
    s_bitcmp1_b32 s97, 6
    s_cbranch_scc1 L_ok_13
    s_sleep 1
    s_branch L_spin_14_l
L_spin_16:
    s_mov_b32 s96, 0
L_spin_16_l:
    v_lshlrev_b32 v15, 2, v1
    v_and_b32 v15, 31, v15
    ds_read_b32 v15, v15 offset:0
    s_add_u32 s96, s96, 1
    s_cmp_gt_u32 s96, 0x40000
    s_cbranch_scc1 L_ok_15
    s_waitcnt lgkmcnt(0)
    v_cmp_ne_u32 vcc, 0, v15
    s_nop 1
    s_mov_b32 s97, vcc_lo
    s_bitcmp1_b32 s97, 7
    s_cbranch_scc1 L_ok_15
    s_sleep 1
    s_branch L_spin_16_l
L_spin_18:
    s_mov_b32 s96, 0
L_spin_18_l:
    v_lshlrev_b32 v15, 2, v1
    v_and_b32 v15, 31, v15
    ds_read_b32 v15, v15 offset:0
    s_add_u32 s96, s96, 1
    s_cmp_gt_u32 s96, 0x40000
    s_cbranch_scc1 L_ok_17
    s_waitcnt lgkmcnt(0)
    v_cmp_ne_u32 vcc, 0, v15
    s_nop 1
    s_mov_b32 s97, vcc_lo
    s_bitcmp1_b32 s97, 0
    s_cbranch_scc1 L_ok_17
    s_sleep 1
    s_branch L_spin_18_l
L_spin_20:
    s_mov_b32 s96, 0
L_spin_20_l:
    v_lshlrev_b32 v15, 2, v1
    v_and_b32 v15, 31, v15
    ds_read_b32 v15, v15 offset:0
    s_add_u32 s96, s96, 1
    s_cmp_gt_u32 s96, 0x40000
    s_cbranch_scc1 L_ok_19
    s_waitcnt lgkmcnt(0)
    v_cmp_ne_u32 vcc, 0, v15
    s_nop 1
    s_mov_b32 s97, vcc_lo
    s_bitcmp1_b32 s97, 1
    s_cbranch_scc1 L_ok_19
    s_sleep 1
    s_branch L_spin_20_l
L_spin_22:
    s_mov_b32 s96, 0
L_spin_22_l:
    v_lshlrev_b32 v15, 2, v1
    v_and_b32 v15, 31, v15
    ds_read_b32 v15, v15 offset:0
    s_add_u32 s96, s96, 1
    s_cmp_gt_u32 s96, 0x40000
    s_cbranch_scc1 L_ok_21
    s_waitcnt lgkmcnt(0)
    v_cmp_ne_u32 vcc, 0, v15
    s_nop 1
    s_mov_b32 s97, vcc_lo
    s_bitcmp1_b32 s97, 2
    s_cbranch_scc1 L_ok_21
    s_sleep 1
    s_branch L_spin_22_l
L_spin_24:
    s_mov_b32 s96, 0
L_spin_24_l:
    v_lshlrev_b32 v15, 2, v1
    v_and_b32 v15, 31, v15
    ds_read_b32 v15, v15 offset:0
    s_add_u32 s96, s96, 1
    s_cmp_gt_u32 s96, 0x40000
    s_cbranch_scc1 L_ok_23
    s_waitcnt lgkmcnt(0)
    v_cmp_ne_u32 vcc, 0, v15
    s_nop 1
    s_mov_b32 s97, vcc_lo
    s_bitcmp1_b32 s97, 3
    s_cbranch_scc1 L_ok_23
    s_sleep 1
    s_branch L_spin_24_l
L_spin_26:
    s_mov_b32 s96, 0
L_spin_26_l:
    v_lshlrev_b32 v15, 2, v1
    v_and_b32 v15, 31, v15
    ds_read_b32 v15, v15 offset:0
    s_add_u32 s96, s96, 1
    s_cmp_gt_u32 s96, 0x40000
    s_cbranch_scc1 L_ok_25
    s_waitcnt lgkmcnt(0)
    v_cmp_ne_u32 vcc, 0, v15
    s_nop 1
    s_mov_b32 s97, vcc_lo
    s_bitcmp1_b32 s97, 4
    s_cbranch_scc1 L_ok_25
    s_sleep 1
    s_branch L_spin_26_l
L_spin_28:
    s_mov_b32 s96, 0
L_spin_28_l:
    v_lshlrev_b32 v15, 2, v1
    v_and_b32 v15, 31, v15
    ds_read_b32 v15, v15 offset:0
    s_add_u32 s96, s96, 1
    s_cmp_gt_u32 s96, 0x40000
    s_cbranch_scc1 L_ok_27
    s_waitcnt lgkmcnt(0)
    v_cmp_ne_u32 vcc, 0, v15
    s_nop 1
    s_mov_b32 s97, vcc_lo
    s_bitcmp1_b32 s97, 5
    s_cbranch_scc1 L_ok_27
    s_sleep 1
    s_branch L_spin_28_l
L_spin_30:
    s_mov_b32 s96, 0
L_spin_30_l:
    s_sleep 1
    ds_read_b32 v15, v7 offset:16
    s_add_u32 s96, s96, 1
    s_cmp_gt_u32 s96, 0x40000
    s_cbranch_scc1 L_ok_29
    s_waitcnt lgkmcnt(0)
    v_readfirstlane_b32 s5, v15
    s_cmp_lt_u32 s5, 8
    s_cbranch_scc1 L_spin_30_l
    s_branch L_ok_29
L_spin_32:
    s_mov_b32 s96, 0
L_spin_32_l:
    v_lshlrev_b32 v15, 2, v1
    v_and_b32 v15, 31, v15
    ds_read_b32 v15, v15 offset:0
    s_add_u32 s96, s96, 1
    s_cmp_gt_u32 s96, 0x40000
    s_cbranch_scc1 L_ok_31
    s_waitcnt lgkmcnt(0)
    v_cmp_ne_u32 vcc, 0, v15
    s_nop 1
    s_mov_b32 s97, vcc_lo
    s_bitcmp1_b32 s97, 6
    s_cbranch_scc1 L_ok_31
    s_sleep 1
    s_branch L_spin_32_l
L_spin_34:
    s_mov_b32 s96, 0
L_spin_34_l:
    v_lshlrev_b32 v15, 2, v1
    v_and_b32 v15, 31, v15
    ds_read_b32 v15, v15 offset:0
    s_add_u32 s96, s96, 1
    s_cmp_gt_u32 s96, 0x40000
    s_cbranch_scc1 L_ok_33
    s_waitcnt lgkmcnt(0)
    v_cmp_ne_u32 vcc, 0, v15
    s_nop 1
    s_mov_b32 s97, vcc_lo
    s_bitcmp1_b32 s97, 7
    s_cbranch_scc1 L_ok_33
    s_sleep 1
    s_branch L_spin_34_l
L_spin_36:
    s_mov_b32 s96, 0
L_spin_36_l:
    s_sleep 1
    ds_read_b32 v15, v7 offset:32
    s_add_u32 s96, s96, 1
    s_cmp_gt_u32 s96, 0x40000
    s_cbranch_scc1 L_ok_35
    s_waitcnt lgkmcnt(0)
    v_readfirstlane_b32 s5, v15
    s_cmp_lt_u32 s5, 8
    s_cbranch_scc1 L_spin_36_l
    s_branch L_ok_35
L_spin_38:
    s_mov_b32 s96, 0
L_spin_38_l:
    s_sleep 1
    ds_read_b32 v15, v2 offset:64
    s_add_u32 s96, s96, 1
    s_cmp_gt_u32 s96, 0x40000
    s_cbranch_scc1 L_ok_37
    s_waitcnt lgkmcnt(0)
    v_readfirstlane_b32 s5, v15
    s_cmp_lt_u32 s5, 2
    s_cbranch_scc1 L_spin_38_l
    s_branch L_ok_37
L_spin_40:
    s_mov_b32 s96, 0
L_spin_40_l:
    s_sleep 1
    ds_read_b32 v15, v2 offset:80
    s_add_u32 s96, s96, 1
    s_cmp_gt_u32 s96, 0x40000
    s_cbranch_scc1 L_ok_39
    s_waitcnt lgkmcnt(0)
    v_readfirstlane_b32 s5, v15
    s_cmp_lt_u32 s5, 2
    s_cbranch_scc1 L_spin_40_l
    s_branch L_ok_39
L_spin_42:
    s_mov_b32 s96, 0
L_spin_42_l:
    v_lshlrev_b32 v15, 2, v1
    v_and_b32 v15, 31, v15
    ds_read_b32 v15, v15 offset:0
    s_add_u32 s96, s96, 1
    s_cmp_gt_u32 s96, 0x40000
    s_cbranch_scc1 L_ok_41
    s_waitcnt lgkmcnt(0)
    v_cmp_ne_u32 vcc, 0, v15
    s_nop 1
    s_mov_b32 s97, vcc_lo
    s_bitcmp1_b32 s97, 0
    s_cbranch_scc1 L_ok_41
    s_sleep 1
    s_branch L_spin_42_l
L_spin_44:
    s_mov_b32 s96, 0
L_spin_44_l:
    v_lshlrev_b32 v15, 2, v1
    v_and_b32 v15, 31, v15
    ds_read_b32 v15, v15 offset:0
    s_add_u32 s96, s96, 1
    s_cmp_gt_u32 s96, 0x40000
    s_cbranch_scc1 L_ok_43
    s_waitcnt lgkmcnt(0)
    v_cmp_ne_u32 vcc, 0, v15
    s_nop 1
    s_mov_b32 s97, vcc_lo
    s_bitcmp1_b32 s97, 1
    s_cbranch_scc1 L_ok_43
    s_sleep 1
    s_branch L_spin_44_l
L_spin_46:
    s_mov_b32 s96, 0
L_spin_46_l:
    v_lshlrev_b32 v15, 2, v1
    v_and_b32 v15, 31, v15
    ds_read_b32 v15, v15 offset:0
    s_add_u32 s96, s96, 1
    s_cmp_gt_u32 s96, 0x40000
    s_cbranch_scc1 L_ok_45
    s_waitcnt lgkmcnt(0)
    v_cmp_ne_u32 vcc, 0, v15
    s_nop 1
    s_mov_b32 s97, vcc_lo
    s_bitcmp1_b32 s97, 2
    s_cbranch_scc1 L_ok_45
    s_sleep 1
    s_branch L_spin_46_l
L_spin_48:
    s_mov_b32 s96, 0
L_spin_48_l:
    v_lshlrev_b32 v15, 2, v1
    v_and_b32 v15, 31, v15
    ds_read_b32 v15, v15 offset:0
    s_add_u32 s96, s96, 1
    s_cmp_gt_u32 s96, 0x40000
    s_cbranch_scc1 L_ok_47
    s_waitcnt lgkmcnt(0)
    v_cmp_ne_u32 vcc, 0, v15
    s_nop 1
    s_mov_b32 s97, vcc_lo
    s_bitcmp1_b32 s97, 0
    s_cbranch_scc1 L_ok_47
    s_sleep 1
    s_branch L_spin_48_l
L_spin_50:
    s_mov_b32 s96, 0
L_spin_50_l:
    v_lshlrev_b32 v15, 2, v1
    v_and_b32 v15, 31, v15
    ds_read_b32 v15, v15 offset:0
    s_add_u32 s96, s96, 1
    s_cmp_gt_u32 s96, 0x40000
    s_cbranch_scc1 L_ok_49
    s_waitcnt lgkmcnt(0)
    v_cmp_ne_u32 vcc, 0, v15
    s_nop 1
    s_mov_b32 s97, vcc_lo
    s_bitcmp1_b32 s97, 1
    s_cbranch_scc1 L_ok_49
    s_sleep 1
    s_branch L_spin_50_l
L_spin_52:
    s_mov_b32 s96, 0
L_spin_52_l:
    v_lshlrev_b32 v15, 2, v1
    v_and_b32 v15, 31, v15
    ds_read_b32 v15, v15 offset:0
    s_add_u32 s96, s96, 1
    s_cmp_gt_u32 s96, 0x40000
    s_cbranch_scc1 L_ok_51
    s_waitcnt lgkmcnt(0)
    v_cmp_ne_u32 vcc, 0, v15
    s_nop 1
    s_mov_b32 s97, vcc_lo
    s_bitcmp1_b32 s97, 3
    s_cbranch_scc1 L_ok_51
    s_sleep 1
    s_branch L_spin_52_l
L_spin_54:
    s_mov_b32 s96, 0
L_spin_54_l:
    v_lshlrev_b32 v15, 2, v1
    v_and_b32 v15, 31, v15
    ds_read_b32 v15, v15 offset:0
    s_add_u32 s96, s96, 1
    s_cmp_gt_u32 s96, 0x40000
    s_cbranch_scc1 L_ok_53
    s_waitcnt lgkmcnt(0)
    v_cmp_ne_u32 vcc, 0, v15
    s_nop 1
    s_mov_b32 s97, vcc_lo
    s_bitcmp1_b32 s97, 4
    s_cbranch_scc1 L_ok_53
    s_sleep 1
    s_branch L_spin_54_l
L_spin_56:
    s_mov_b32 s96, 0
L_spin_56_l:
    v_lshlrev_b32 v15, 2, v1
    v_and_b32 v15, 31, v15
    ds_read_b32 v15, v15 offset:0
    s_add_u32 s96, s96, 1
    s_cmp_gt_u32 s96, 0x40000
    s_cbranch_scc1 L_ok_55
    s_waitcnt lgkmcnt(0)
    v_cmp_ne_u32 vcc, 0, v15
    s_nop 1
    s_mov_b32 s97, vcc_lo
    s_bitcmp1_b32 s97, 5
    s_cbranch_scc1 L_ok_55
    s_sleep 1
    s_branch L_spin_56_l
L_spin_58:
    s_mov_b32 s96, 0
L_spin_58_l:
    v_lshlrev_b32 v15, 2, v1
    v_and_b32 v15, 31, v15
    ds_read_b32 v15, v15 offset:0
    s_add_u32 s96, s96, 1
    s_cmp_gt_u32 s96, 0x40000
    s_cbranch_scc1 L_ok_57
    s_waitcnt lgkmcnt(0)
    v_cmp_ne_u32 vcc, 0, v15
    s_nop 1
    s_mov_b32 s97, vcc_lo
    s_bitcmp1_b32 s97, 6
    s_cbranch_scc1 L_ok_57
    s_sleep 1
    s_branch L_spin_58_l
L_spin_60:
    s_mov_b32 s96, 0
L_spin_60_l:
    v_lshlrev_b32 v15, 2, v1
    v_and_b32 v15, 31, v15
    ds_read_b32 v15, v15 offset:0
    s_add_u32 s96, s96, 1
    s_cmp_gt_u32 s96, 0x40000
    s_cbranch_scc1 L_ok_59
    s_waitcnt lgkmcnt(0)
    v_cmp_ne_u32 vcc, 0, v15
    s_nop 1
    s_mov_b32 s97, vcc_lo
    s_bitcmp1_b32 s97, 7
    s_cbranch_scc1 L_ok_59
    s_sleep 1
    s_branch L_spin_60_l
L_spin_62:
    s_mov_b32 s96, 0
L_spin_62_l:
    v_lshlrev_b32 v15, 2, v1
    v_and_b32 v15, 31, v15
    ds_read_b32 v15, v15 offset:0
    s_add_u32 s96, s96, 1
    s_cmp_gt_u32 s96, 0x40000
    s_cbranch_scc1 L_ok_61
    s_waitcnt lgkmcnt(0)
    v_cmp_ne_u32 vcc, 0, v15
    s_nop 1
    s_mov_b32 s97, vcc_lo
    s_bitcmp1_b32 s97, 0
    s_cbranch_scc1 L_ok_61
    s_sleep 1
    s_branch L_spin_62_l
L_spin_64:
    s_mov_b32 s96, 0
L_spin_64_l:
    v_lshlrev_b32 v15, 2, v1
    v_and_b32 v15, 31, v15
    ds_read_b32 v15, v15 offset:0
    s_add_u32 s96, s96, 1
    s_cmp_gt_u32 s96, 0x40000
    s_cbranch_scc1 L_ok_63
    s_waitcnt lgkmcnt(0)
    v_cmp_ne_u32 vcc, 0, v15
    s_nop 1
    s_mov_b32 s97, vcc_lo
    s_bitcmp1_b32 s97, 1
    s_cbranch_scc1 L_ok_63
    s_sleep 1
    s_branch L_spin_64_l
L_spin_66:
    s_mov_b32 s96, 0
L_spin_66_l:
    v_lshlrev_b32 v15, 2, v1
    v_and_b32 v15, 31, v15
    ds_read_b32 v15, v15 offset:0
    s_add_u32 s96, s96, 1
    s_cmp_gt_u32 s96, 0x40000
    s_cbranch_scc1 L_ok_65
    s_waitcnt lgkmcnt(0)
    v_cmp_ne_u32 vcc, 0, v15
    s_nop 1
    s_mov_b32 s97, vcc_lo
    s_bitcmp1_b32 s97, 2
    s_cbranch_scc1 L_ok_65
    s_sleep 1
    s_branch L_spin_66_l
L_spin_68:
    s_mov_b32 s96, 0
L_spin_68_l:
    v_lshlrev_b32 v15, 2, v1
    v_and_b32 v15, 31, v15
    ds_read_b32 v15, v15 offset:0
    s_add_u32 s96, s96, 1
    s_cmp_gt_u32 s96, 0x40000
    s_cbranch_scc1 L_ok_67
    s_waitcnt lgkmcnt(0)
    v_cmp_ne_u32 vcc, 0, v15
    s_nop 1
    s_mov_b32 s97, vcc_lo
    s_bitcmp1_b32 s97, 3
    s_cbranch_scc1 L_ok_67
    s_sleep 1
    s_branch L_spin_68_l
L_spin_70:
    s_mov_b32 s96, 0
L_spin_70_l:
    v_lshlrev_b32 v15, 2, v1
    v_and_b32 v15, 31, v15
    ds_read_b32 v15, v15 offset:0
    s_add_u32 s96, s96, 1
    s_cmp_gt_u32 s96, 0x40000
    s_cbranch_scc1 L_ok_69
    s_waitcnt lgkmcnt(0)
    v_cmp_ne_u32 vcc, 0, v15
    s_nop 1
    s_mov_b32 s97, vcc_lo
    s_bitcmp1_b32 s97, 0
    s_cbranch_scc1 L_ok_69
    s_sleep 1
    s_branch L_spin_70_l
L_spin_72:
    s_mov_b32 s96, 0
L_spin_72_l:
    v_lshlrev_b32 v15, 2, v1
    v_and_b32 v15, 31, v15
    ds_read_b32 v15, v15 offset:0
    s_add_u32 s96, s96, 1
    s_cmp_gt_u32 s96, 0x40000
    s_cbranch_scc1 L_ok_71
    s_waitcnt lgkmcnt(0)
    v_cmp_ne_u32 vcc, 0, v15
    s_nop 1
    s_mov_b32 s97, vcc_lo
    s_bitcmp1_b32 s97, 1
    s_cbranch_scc1 L_ok_71
    s_sleep 1
    s_branch L_spin_72_l
L_spin_74:
    s_mov_b32 s96, 0
L_spin_74_l:
    v_lshlrev_b32 v15, 2, v1
    v_and_b32 v15, 31, v15
    ds_read_b32 v15, v15 offset:0
    s_add_u32 s96, s96, 1
    s_cmp_gt_u32 s96, 0x40000
    s_cbranch_scc1 L_ok_73
    s_waitcnt lgkmcnt(0)
    v_cmp_ne_u32 vcc, 0, v15
    s_nop 1
    s_mov_b32 s97, vcc_lo
    s_bitcmp1_b32 s97, 4
    s_cbranch_scc1 L_ok_73
    s_sleep 1
    s_branch L_spin_74_l
L_spin_76:
    s_mov_b32 s96, 0
L_spin_76_l:
    v_lshlrev_b32 v15, 2, v1
    v_and_b32 v15, 31, v15
    ds_read_b32 v15, v15 offset:0
    s_add_u32 s96, s96, 1
    s_cmp_gt_u32 s96, 0x40000
    s_cbranch_scc1 L_ok_75
    s_waitcnt lgkmcnt(0)
    v_cmp_ne_u32 vcc, 0, v15
    s_nop 1
    s_mov_b32 s97, vcc_lo
    s_bitcmp1_b32 s97, 5
    s_cbranch_scc1 L_ok_75
    s_sleep 1
    s_branch L_spin_76_l
L_spin_78:
    s_mov_b32 s96, 0
L_spin_78_l:
    s_sleep 1
    ds_read_b32 v15, v7 offset:32
    s_add_u32 s96, s96, 1
    s_cmp_gt_u32 s96, 0x40000
    s_cbranch_scc1 L_ok_77
    s_waitcnt lgkmcnt(0)
    v_readfirstlane_b32 s5, v15
    s_cmp_lt_u32 s5, s7
    s_cbranch_scc1 L_spin_78_l
    s_branch L_ok_77
L_spin_81:
    s_mov_b32 s96, 0
L_spin_81_l:
    s_sleep 1
    ds_read_b32 v15, v7 offset:48
    s_add_u32 s96, s96, 1
    s_cmp_gt_u32 s96, 0x40000
    s_cbranch_scc1 L_ok_80
    s_waitcnt lgkmcnt(0)
    v_readfirstlane_b32 s5, v15
    s_cmp_lt_u32 s5, s7
    s_cbranch_scc1 L_spin_81_l
    s_branch L_ok_80
L_end:
    s_endpgm
.section .rodata,"a"
.p2align 6
.amdhsa_kernel concat_heads__ssm_conv_h3__ssm_conv_s4__prompt_kernel
  .amdhsa_next_free_vgpr 256
  .amdhsa_next_free_sgpr 102
  .amdhsa_accum_offset 256
  .amdhsa_group_segment_fixed_size 0
  .amdhsa_kernarg_size 144
  .amdhsa_user_sgpr_count 2
  .amdhsa_user_sgpr_kernarg_segment_ptr 1
  .amdhsa_system_sgpr_workgroup_id_x 1
.end_amdhsa_kernel
```
